```python
import torch

def _softmax(x, axis=-1):
    return torch.softmax(x, dim=axis)
def _gelu(x):
    return torch.nn.functional.gelu(x, approximate="tanh")
def _silu(x):
    return torch.nn.functional.silu(x)
def _sigmoid(x):
    return torch.sigmoid(x)
def _layernorm(x, axis=-1, eps=1e-5):
    m = x.mean(dim=axis, keepdim=True)
    v = x.var(dim=axis, keepdim=True, unbiased=False)
    return (x - m) / torch.sqrt(v + eps)
def _scatter_add(tgt, idx, src, axis=0):
    return tgt.clone().index_add_(axis, idx, src)
def _segment_sum(src, seg, n):
    out = torch.zeros((n,) + src.shape[1:], dtype=src.dtype)
    return out.index_add_(0, seg, src)
def _pad(x, pw):
    flat = tuple(v for pair in reversed(pw) for v in pair)
    return torch.nn.functional.pad(x, flat)

kernel_name = 'gated_mix__ssm_conv_s5__softmax_full_mha__prompt'

def setup_inputs():

    _w = (lambda a: (lambda t: t.to(torch.bfloat16) if t.is_floating_point() else t)(torch.as_tensor(a)))
    def _A_setup():
        B, S, D = 1, 2048, 512
        P = D
        Lambda_re = -0.5 * (lambda _x: torch.exp(torch.as_tensor(_x)))((lambda *s: torch.randn(*s, dtype=torch.bfloat16) * 0.4)(P))
        Lambda_im = (lambda *s: torch.randn(*s, dtype=torch.bfloat16) * 0.8)(P) * 1.0
        B_re = (lambda *s: torch.randn(*s, dtype=torch.bfloat16) * 0.8)(P, D) * (D ** -0.5)
        B_im = (lambda *s: torch.randn(*s, dtype=torch.bfloat16) * 0.8)(P, D) * (D ** -0.5)
        C_re = (lambda *s: torch.randn(*s, dtype=torch.bfloat16) * 0.8)(D, P) * (P ** -0.5)
        C_im = (lambda *s: torch.randn(*s, dtype=torch.bfloat16) * 0.8)(D, P) * (P ** -0.5)
        log_dt = (lambda *s: torch.randn(*s, dtype=torch.bfloat16) * 0.4)(P) * 0.3 - 2.0
        Dskip = (lambda *s: torch.randn(*s, dtype=torch.bfloat16) * 0.1)(D)
        return {
            "x": _w((lambda *s: torch.randn(*s, dtype=torch.bfloat16) * 0.05)(B, S, D)),
            "Lambda_re": _w(Lambda_re),
            "Lambda_im": _w(Lambda_im),
            "B_re": _w(B_re),
            "B_im": _w(B_im),
            "C_re": _w(C_re),
            "C_im": _w(C_im),
            "log_dt": _w(log_dt),
            "Dskip": _w(Dskip),
        }
    _A_in = _A_setup()

    def _B_setup():
        B, S, D = 1, 2048, 512
        return {
            "x": _w((lambda *s: torch.randn(*s, dtype=torch.bfloat16) * 0.05)(B, S, D)),
            "wqkv": _w((lambda *s: torch.randn(*s, dtype=torch.bfloat16) * 0.8)(D, 3 * D)),
            "wo": _w((lambda *s: torch.randn(*s, dtype=torch.bfloat16) * 0.05)(D, D)),
        }
    _B_in = _B_setup()

    return {
        "A_x": _A_in["x"],
        "A_Lambda_re": _A_in["Lambda_re"],
        "A_Lambda_im": _A_in["Lambda_im"],
        "A_B_re": _A_in["B_re"],
        "A_B_im": _A_in["B_im"],
        "A_C_re": _A_in["C_re"],
        "A_C_im": _A_in["C_im"],
        "A_log_dt": _A_in["log_dt"],
        "A_Dskip": _A_in["Dskip"],
        "B_x": _B_in["x"],
        "B_wqkv": _B_in["wqkv"],
        "B_wo": _B_in["wo"],
        "gate_w": _w((lambda *s: torch.randn(*s, dtype=torch.bfloat16) * 0.05)(512) * 16.0),
    }

def reference(A_x, A_Lambda_re, A_Lambda_im, A_B_re, A_B_im, A_C_re, A_C_im, A_log_dt, A_Dskip, B_x, B_wqkv, B_wo, gate_w):
    def _A_ref(x, Lambda_re, Lambda_im, B_re, B_im, C_re, C_im, log_dt, Dskip):
        Bsz, L, H = x.shape
        Lam = Lambda_re + 1j * Lambda_im
        Bmat = B_re + 1j * B_im
        Cmat = C_re + 1j * C_im
        dt = torch.exp(log_dt)
        Lam_bar = torch.exp(dt * Lam)
        B_bar = ((Lam_bar - 1.0) / Lam)[:, None] * Bmat
        Bu = torch.einsum("bld,pd->blp", x + 0j, B_bar)
        h = torch.zeros_like(Bu[:, 0, :])
        hs = []
        for t in range(L):
            h = Lam_bar[None, :] * h + Bu[:, t, :]
            hs.append(h)
        hseq = torch.stack(hs, 1)
        y = 2.0 * torch.einsum("blp,dp->bld", hseq, Cmat).real + x * Dskip[None, None, :]
        return y

    def _B_ref(x, wqkv, wo):
        B, S, D = x.shape
        H = 32; Dh = D // H
        qkv = (lambda x, *d: x.permute(*d))((x @ wqkv).reshape(B, S, 3, H, Dh), 2, 0, 3, 1, 4)
        q, k, v = qkv[0], qkv[1], qkv[2]
        scale = Dh ** -0.5
        scores = torch.einsum("bhqd,bhkd->bhqk", q, k) * scale
        p = _softmax(scores, axis=-1)
        o = torch.einsum("bhqk,bhkd->bhqd", p, v)
        return (lambda x, *d: x.permute(*d))(o, 0, 2, 1, 3).reshape(B, S, D) @ wo

    x = A_x
    g = _sigmoid((x * gate_w).sum(-1, keepdims=True))
    a = _A_ref(x, A_Lambda_re, A_Lambda_im, A_B_re, A_B_im, A_C_re, A_C_im, A_log_dt, A_Dskip)
    b = _B_ref(x, B_wqkv, B_wo)
    return g * a + (1 - g) * b
```

```asm
; @launch grid=(256,1,1) block=(768,1,1) lds=163840
.amdgcn_target "amdgcn-amd-amdhsa--gfx950"
.text
.globl gated_mix__ssm_conv_s5__softmax_full_mha__prompt_kernel
.p2align 8
.type gated_mix__ssm_conv_s5__softmax_full_mha__prompt_kernel,@function
gated_mix__ssm_conv_s5__softmax_full_mha__prompt_kernel:
  s_cmp_ge_u32 s2, 256
  s_cbranch_scc1 L_exit
  s_load_dwordx16 s[60:75], s[0:1], 0
  s_load_dwordx16 s[76:91], s[0:1], 64

  v_lshrrev_b32 v1, 6, v0
  v_and_b32 v0, 63, v0
  s_and_b32 s48, s2, 7
  v_readfirstlane_b32 s3, v1
  s_lshr_b32 s49, s2, 3
  s_lshr_b32 s4, s48, 2
  s_lshl_b32 s4, s4, 4
  s_and_b32 s50, s49, 15
  s_add_u32 s4, s4, s50
  s_and_b32 s5, s48, 3
  s_lshl_b32 s5, s5, 1
  s_lshr_b32 s50, s49, 4
  s_add_u32 s5, s5, s50
  s_lshl_b32 s7, s5, 2
  s_add_u32 s7, s7, s4
  s_and_b32 s7, s7, 7
  s_cmp_ge_u32 s3, 8
  s_cbranch_scc1 L_swave
  s_cmp_ge_u32 s3, 4
  s_cbranch_scc0 L_comp

  s_sub_u32 s51, s3, 4
  v_lshrrev_b32 v4, 3, v0
  v_and_b32 v5, 7, v0
  s_lshl_b32 s48, s51, 4
  v_add_u32 v6, s48, v4
  v_lshlrev_b32 v1, 10, v6
  v_mul_u32_u24 v3, 3072, v6
  v_lshrrev_b32 v4, 1, v4
  v_xor_b32 v6, v5, v4
  v_lshl_add_u32 v1, v6, 4, v1
  v_xor_b32 v2, 64, v1
  v_add_u32 v2, 8192, v2
  v_and_b32 v4, 1, v4
  v_lshlrev_b32 v4, 2, v4
  v_xor_b32 v6, v5, v4
  v_lshl_add_u32 v3, v6, 4, v3
  s_lshl_b32 s52, s4, 16
  s_lshl_b32 s53, s5, 16
  s_lshl_b32 s54, s5, 7
  s_lshl_b32 s55, s51, 11
  s_mov_b32 s10, 2097152
  s_mov_b32 s11, 0x20000
  s_mov_b32 s14, 1572864
  s_mov_b32 s15, 0x20000
  s_waitcnt lgkmcnt(0)
  s_mov_b64 s[8:9], s[60:61]
  s_mov_b64 s[12:13], s[80:81]
  s_mov_b64 s[24:25], s[66:67]
  s_mov_b64 s[28:29], s[68:69]
  s_setprio 3
  s_add_u32 s60, s7, 0
  s_and_b32 s60, s60, 7
  s_lshl_b32 s60, s60, 7
  s_add_u32 s56, s52, s60
  s_add_u32 m0, s55, 0
  s_nop 0
  buffer_load_dwordx4 v1, s[8:11], s56 offen lds
  s_add_u32 m0, s55, 1024
  s_nop 0
  buffer_load_dwordx4 v2, s[8:11], s56 offen lds
  s_mul_i32 s57, s60, 1536
  s_add_u32 s57, s57, s54
  s_add_u32 m0, s55, 65536
  s_add_u32 s56, s57, 1024
  buffer_load_dwordx4 v3, s[12:15], s56 offen lds
  s_add_u32 m0, s55, 66560
  s_add_u32 s56, s57, 25600
  buffer_load_dwordx4 v3, s[12:15], s56 offen lds
  s_mul_i32 s57, s60, 1536
  s_add_u32 s57, s57, s54
  s_add_u32 m0, s55, 73728
  s_add_u32 s56, s57, 2048
  buffer_load_dwordx4 v3, s[12:15], s56 offen lds
  s_add_u32 m0, s55, 74752
  s_add_u32 s56, s57, 26624
  buffer_load_dwordx4 v3, s[12:15], s56 offen lds
  s_setprio 2
  s_add_u32 s61, s7, 1
  s_and_b32 s61, s61, 7
  s_lshl_b32 s61, s61, 7
  s_add_u32 s56, s52, s61
  s_add_u32 m0, s55, 8192
  s_nop 0
  buffer_load_dwordx4 v1, s[8:11], s56 offen lds
  s_add_u32 m0, s55, 9216
  s_nop 0
  buffer_load_dwordx4 v2, s[8:11], s56 offen lds
  s_mul_i32 s57, s61, 1536
  s_add_u32 s57, s57, s54
  s_add_u32 m0, s55, 81920
  s_add_u32 s56, s57, 1024
  buffer_load_dwordx4 v3, s[12:15], s56 offen lds
  s_add_u32 m0, s55, 82944
  s_add_u32 s56, s57, 25600
  buffer_load_dwordx4 v3, s[12:15], s56 offen lds
  s_mul_i32 s57, s61, 1536
  s_add_u32 s57, s57, s54
  s_add_u32 m0, s55, 90112
  s_add_u32 s56, s57, 2048
  buffer_load_dwordx4 v3, s[12:15], s56 offen lds
  s_add_u32 m0, s55, 91136
  s_add_u32 s56, s57, 26624
  buffer_load_dwordx4 v3, s[12:15], s56 offen lds
  s_setprio 0
  s_mov_b32 s26, 524288
  s_mov_b32 s27, 0x20000
  s_mov_b32 s30, 524288
  s_mov_b32 s31, 0x20000
  s_mov_b32 s18, 33554432
  s_mov_b32 s19, 0x20000
  s_mov_b64 s[16:17], s[90:91]
  s_load_dword s6, s[16:17], 0
  v_lshlrev_b32 v160, 4, v0
  v_and_b32 v161, 15, v0
  v_lshlrev_b32 v161, 4, v161
  v_lshrrev_b32 v162, 5, v0
  v_lshl_add_u32 v161, v162, 8, v161
  s_mul_i32 s70, s3, 3072
  s_add_u32 s70, s70, 131072
  v_add_u32 v165, s70, v161
  v_mov_b32 v112, 0
  v_mov_b32 v113, 0
  v_mov_b32 v114, 0
  v_mov_b32 v115, 0
  v_mov_b32 v116, 0
  v_mov_b32 v117, 0
  v_mov_b32 v118, 0
  v_mov_b32 v119, 0
  v_mov_b32 v120, 0
  v_mov_b32 v121, 0
  v_mov_b32 v122, 0
  v_mov_b32 v123, 0
  v_mov_b32 v124, 0
  v_mov_b32 v125, 0
  v_mov_b32 v126, 0
  v_mov_b32 v127, 0
  v_mov_b32 v128, 0
  v_mov_b32 v129, 0
  v_mov_b32 v130, 0
  v_mov_b32 v131, 0
  v_mov_b32 v132, 0
  v_mov_b32 v133, 0
  v_mov_b32 v134, 0
  v_mov_b32 v135, 0
  v_mov_b32 v136, 0
  v_mov_b32 v137, 0
  v_mov_b32 v138, 0
  v_mov_b32 v139, 0
  v_mov_b32 v140, 0
  v_mov_b32 v141, 0
  v_mov_b32 v142, 0
  v_mov_b32 v143, 0
  v_and_b32 v162, 27, v0
  v_cmp_eq_u32 vcc, 16, v162
  v_mov_b32 v163, 0x3f803f80
  v_mov_b32 v164, 0xdddddddd
  v_cndmask_b32 v163, 0, v163, vcc
  v_mov_b32 v144, v163
  v_mov_b32 v145, v163
  v_mov_b32 v146, v163
  v_mov_b32 v147, v163
  v_mov_b32 v148, v163
  v_mov_b32 v149, v163
  v_mov_b32 v150, v163
  v_mov_b32 v151, v163
  v_mov_b32 v152, v163
  v_mov_b32 v153, v163
  v_mov_b32 v154, v163
  v_mov_b32 v155, v163
  v_mov_b32 v156, v163
  v_mov_b32 v157, v163
  v_mov_b32 v158, v163
  v_mov_b32 v159, v163
  s_waitcnt vmcnt(6)
  s_barrier
  s_add_u32 s62, s7, 2
  s_and_b32 s62, s62, 7
  s_lshl_b32 s62, s62, 7
  s_add_u32 s56, s52, s62
  s_add_u32 m0, s55, 16384
  s_nop 0
  buffer_load_dwordx4 v1, s[8:11], s56 offen lds
  s_add_u32 m0, s55, 17408
  s_nop 0
  buffer_load_dwordx4 v2, s[8:11], s56 offen lds
  s_mul_i32 s57, s62, 1536
  s_add_u32 s57, s57, s54
  s_add_u32 m0, s55, 98304
  s_add_u32 s56, s57, 1024
  buffer_load_dwordx4 v3, s[12:15], s56 offen lds
  s_add_u32 m0, s55, 99328
  s_add_u32 s56, s57, 25600
  buffer_load_dwordx4 v3, s[12:15], s56 offen lds
  s_mul_i32 s57, s62, 1536
  s_add_u32 s57, s57, s54
  s_add_u32 m0, s55, 131072
  s_add_u32 s56, s57, 2048
  buffer_load_dwordx4 v3, s[12:15], s56 offen lds
  s_add_u32 m0, s55, 132096
  s_add_u32 s56, s57, 26624
  buffer_load_dwordx4 v3, s[12:15], s56 offen lds
  s_add_u32 s63, s7, 3
  s_and_b32 s63, s63, 7
  s_lshl_b32 s63, s63, 7
  s_add_u32 s56, s52, s63
  s_add_u32 m0, s55, 24576
  s_nop 0
  buffer_load_dwordx4 v1, s[8:11], s56 offen lds
  s_add_u32 m0, s55, 25600
  s_nop 0
  buffer_load_dwordx4 v2, s[8:11], s56 offen lds
  s_mul_i32 s57, s63, 1536
  s_add_u32 s57, s57, s54
  s_add_u32 m0, s55, 139264
  s_add_u32 s56, s57, 1024
  buffer_load_dwordx4 v3, s[12:15], s56 offen lds
  s_add_u32 m0, s55, 140288
  s_add_u32 s56, s57, 25600
  buffer_load_dwordx4 v3, s[12:15], s56 offen lds
  s_mul_i32 s57, s63, 1536
  s_add_u32 s57, s57, s54
  s_add_u32 m0, s55, 147456
  s_add_u32 s56, s57, 2048
  buffer_load_dwordx4 v3, s[12:15], s56 offen lds
  s_add_u32 m0, s55, 148480
  s_add_u32 s56, s57, 26624
  buffer_load_dwordx4 v3, s[12:15], s56 offen lds
  s_waitcnt vmcnt(12)
  s_barrier
  s_add_u32 s64, s7, 4
  s_and_b32 s64, s64, 7
  s_lshl_b32 s64, s64, 7
  s_add_u32 s56, s52, s64
  s_add_u32 m0, s55, 32768
  s_nop 0
  buffer_load_dwordx4 v1, s[8:11], s56 offen lds
  s_add_u32 m0, s55, 33792
  s_nop 0
  buffer_load_dwordx4 v2, s[8:11], s56 offen lds
  s_mul_i32 s57, s64, 1536
  s_add_u32 s57, s57, s54
  s_add_u32 m0, s55, 65536
  s_add_u32 s56, s57, 1024
  buffer_load_dwordx4 v3, s[12:15], s56 offen lds
  s_add_u32 m0, s55, 66560
  s_add_u32 s56, s57, 25600
  buffer_load_dwordx4 v3, s[12:15], s56 offen lds
  s_mul_i32 s57, s64, 1536
  s_add_u32 s57, s57, s54
  s_add_u32 m0, s55, 73728
  s_add_u32 s56, s57, 2048
  buffer_load_dwordx4 v3, s[12:15], s56 offen lds
  s_add_u32 m0, s55, 74752
  s_add_u32 s56, s57, 26624
  buffer_load_dwordx4 v3, s[12:15], s56 offen lds
  s_mul_i32 s57, s60, 1536
  s_add_u32 s57, s57, s54
  s_add_u32 m0, s55, 106496
  s_add_u32 s56, s57, 0
  buffer_load_dwordx4 v3, s[12:15], s56 offen lds
  s_add_u32 m0, s55, 107520
  s_add_u32 s56, s57, 24576
  buffer_load_dwordx4 v3, s[12:15], s56 offen lds
  s_add_u32 s56, s53, s60
  s_add_u32 m0, s55, 114688
  s_nop 0
  buffer_load_dwordx4 v1, s[24:27], s56 offen lds
  s_add_u32 m0, s55, 115712
  s_nop 0
  buffer_load_dwordx4 v2, s[24:27], s56 offen lds
  s_add_u32 s56, s53, s60
  s_add_u32 m0, s55, 122880
  s_nop 0
  buffer_load_dwordx4 v1, s[28:31], s56 offen lds
  s_add_u32 m0, s55, 123904
  s_nop 0
  buffer_load_dwordx4 v2, s[28:31], s56 offen lds
  s_waitcnt vmcnt(18)
  s_barrier
  s_add_u32 s65, s7, 5
  s_and_b32 s65, s65, 7
  s_lshl_b32 s65, s65, 7
  s_add_u32 s56, s52, s65
  s_add_u32 m0, s55, 40960
  s_nop 0
  buffer_load_dwordx4 v1, s[8:11], s56 offen lds
  s_add_u32 m0, s55, 41984
  s_nop 0
  buffer_load_dwordx4 v2, s[8:11], s56 offen lds
  s_mul_i32 s57, s65, 1536
  s_add_u32 s57, s57, s54
  s_add_u32 m0, s55, 81920
  s_add_u32 s56, s57, 1024
  buffer_load_dwordx4 v3, s[12:15], s56 offen lds
  s_add_u32 m0, s55, 82944
  s_add_u32 s56, s57, 25600
  buffer_load_dwordx4 v3, s[12:15], s56 offen lds
  s_mul_i32 s57, s65, 1536
  s_add_u32 s57, s57, s54
  s_add_u32 m0, s55, 90112
  s_add_u32 s56, s57, 2048
  buffer_load_dwordx4 v3, s[12:15], s56 offen lds
  s_add_u32 m0, s55, 91136
  s_add_u32 s56, s57, 26624
  buffer_load_dwordx4 v3, s[12:15], s56 offen lds
  s_waitcnt vmcnt(18)
  s_barrier
  s_add_u32 s66, s7, 6
  s_and_b32 s66, s66, 7
  s_lshl_b32 s66, s66, 7
  s_add_u32 s56, s52, s66
  s_add_u32 m0, s55, 49152
  s_nop 0
  buffer_load_dwordx4 v1, s[8:11], s56 offen lds
  s_add_u32 m0, s55, 50176
  s_nop 0
  buffer_load_dwordx4 v2, s[8:11], s56 offen lds
  s_mul_i32 s57, s66, 1536
  s_add_u32 s57, s57, s54
  s_add_u32 m0, s55, 98304
  s_add_u32 s56, s57, 1024
  buffer_load_dwordx4 v3, s[12:15], s56 offen lds
  s_add_u32 m0, s55, 99328
  s_add_u32 s56, s57, 25600
  buffer_load_dwordx4 v3, s[12:15], s56 offen lds
  s_mul_i32 s57, s66, 1536
  s_add_u32 s57, s57, s54
  s_add_u32 m0, s55, 131072
  s_add_u32 s56, s57, 2048
  buffer_load_dwordx4 v3, s[12:15], s56 offen lds
  s_add_u32 m0, s55, 132096
  s_add_u32 s56, s57, 26624
  buffer_load_dwordx4 v3, s[12:15], s56 offen lds
  s_waitcnt vmcnt(12)
  s_barrier
  s_add_u32 s67, s7, 7
  s_and_b32 s67, s67, 7
  s_lshl_b32 s67, s67, 7
  s_add_u32 s56, s52, s67
  s_add_u32 m0, s55, 57344
  s_nop 0
  buffer_load_dwordx4 v1, s[8:11], s56 offen lds
  s_add_u32 m0, s55, 58368
  s_nop 0
  buffer_load_dwordx4 v2, s[8:11], s56 offen lds
  s_mul_i32 s57, s67, 1536
  s_add_u32 s57, s57, s54
  s_add_u32 m0, s55, 139264
  s_add_u32 s56, s57, 1024
  buffer_load_dwordx4 v3, s[12:15], s56 offen lds
  s_add_u32 m0, s55, 140288
  s_add_u32 s56, s57, 25600
  buffer_load_dwordx4 v3, s[12:15], s56 offen lds
  s_mul_i32 s57, s67, 1536
  s_add_u32 s57, s57, s54
  s_add_u32 m0, s55, 147456
  s_add_u32 s56, s57, 2048
  buffer_load_dwordx4 v3, s[12:15], s56 offen lds
  s_add_u32 m0, s55, 148480
  s_add_u32 s56, s57, 26624
  buffer_load_dwordx4 v3, s[12:15], s56 offen lds
  s_waitcnt vmcnt(12)
  s_barrier
  s_add_u32 s56, s53, s61
  s_add_u32 m0, s55, 65536
  s_nop 0
  buffer_load_dwordx4 v1, s[24:27], s56 offen lds
  s_add_u32 m0, s55, 66560
  s_nop 0
  buffer_load_dwordx4 v2, s[24:27], s56 offen lds
  s_add_u32 s56, s53, s61
  s_add_u32 m0, s55, 73728
  s_nop 0
  buffer_load_dwordx4 v1, s[28:31], s56 offen lds
  s_add_u32 m0, s55, 74752
  s_nop 0
  buffer_load_dwordx4 v2, s[28:31], s56 offen lds
  s_mul_i32 s57, s61, 1536
  s_add_u32 s57, s57, s54
  s_add_u32 m0, s55, 122880
  s_add_u32 s56, s57, 0
  buffer_load_dwordx4 v3, s[12:15], s56 offen lds
  s_add_u32 m0, s55, 123904
  s_add_u32 s56, s57, 24576
  buffer_load_dwordx4 v3, s[12:15], s56 offen lds
  s_waitcnt vmcnt(12)
  s_barrier
  s_mul_i32 s57, s62, 1536
  s_add_u32 s57, s57, s54
  s_add_u32 m0, s55, 114688
  s_add_u32 s56, s57, 0
  buffer_load_dwordx4 v3, s[12:15], s56 offen lds
  s_add_u32 m0, s55, 115712
  s_add_u32 s56, s57, 24576
  buffer_load_dwordx4 v3, s[12:15], s56 offen lds
  s_add_u32 s56, s53, s62
  s_add_u32 m0, s55, 90112
  s_nop 0
  buffer_load_dwordx4 v1, s[24:27], s56 offen lds
  s_add_u32 m0, s55, 91136
  s_nop 0
  buffer_load_dwordx4 v2, s[24:27], s56 offen lds
  s_add_u32 s56, s53, s62
  s_add_u32 m0, s55, 81920
  s_nop 0
  buffer_load_dwordx4 v1, s[28:31], s56 offen lds
  s_add_u32 m0, s55, 82944
  s_nop 0
  buffer_load_dwordx4 v2, s[28:31], s56 offen lds
  s_waitcnt lgkmcnt(0)
  s_mul_i32 s6, s6, 0x9E3779B1
  s_add_u32 s6, s6, 0x7F4A7C15
  s_waitcnt vmcnt(8)
  s_barrier
  s_mul_i32 s57, s63, 1536
  s_add_u32 s57, s57, s54
  s_add_u32 m0, s55, 131072
  s_add_u32 s56, s57, 0
  buffer_load_dwordx4 v3, s[12:15], s56 offen lds
  s_add_u32 m0, s55, 132096
  s_add_u32 s56, s57, 24576
  buffer_load_dwordx4 v3, s[12:15], s56 offen lds
  s_mul_i32 s57, s64, 1536
  s_add_u32 s57, s57, s54
  s_add_u32 m0, s55, 98304
  s_add_u32 s56, s57, 0
  buffer_load_dwordx4 v3, s[12:15], s56 offen lds
  s_add_u32 m0, s55, 99328
  s_add_u32 s56, s57, 24576
  buffer_load_dwordx4 v3, s[12:15], s56 offen lds
  s_waitcnt vmcnt(4)
  s_barrier
  s_mul_i32 s57, s65, 1536
  s_add_u32 s57, s57, s54
  s_add_u32 m0, s55, 147456
  s_add_u32 s56, s57, 0
  buffer_load_dwordx4 v3, s[12:15], s56 offen lds
  s_add_u32 m0, s55, 148480
  s_add_u32 s56, s57, 24576
  buffer_load_dwordx4 v3, s[12:15], s56 offen lds
  s_add_u32 s56, s53, s63
  s_add_u32 m0, s55, 139264
  s_nop 0
  buffer_load_dwordx4 v1, s[24:27], s56 offen lds
  s_add_u32 m0, s55, 140288
  s_nop 0
  buffer_load_dwordx4 v2, s[24:27], s56 offen lds
  s_add_u32 s56, s53, s63
  s_add_u32 m0, s55, 73728
  s_nop 0
  buffer_load_dwordx4 v1, s[28:31], s56 offen lds
  s_add_u32 m0, s55, 74752
  s_nop 0
  buffer_load_dwordx4 v2, s[28:31], s56 offen lds
  s_mul_i32 s57, s66, 1536
  s_add_u32 s57, s57, s54
  s_add_u32 m0, s55, 65536
  s_add_u32 s56, s57, 0
  buffer_load_dwordx4 v3, s[12:15], s56 offen lds
  s_add_u32 m0, s55, 66560
  s_add_u32 s56, s57, 24576
  buffer_load_dwordx4 v3, s[12:15], s56 offen lds
  s_waitcnt vmcnt(2)
  s_barrier
  s_mul_i32 s57, s67, 1536
  s_add_u32 s57, s57, s54
  s_add_u32 m0, s55, 122880
  s_add_u32 s56, s57, 0
  buffer_load_dwordx4 v3, s[12:15], s56 offen lds
  s_add_u32 m0, s55, 123904
  s_add_u32 s56, s57, 24576
  buffer_load_dwordx4 v3, s[12:15], s56 offen lds
  s_add_u32 s56, s53, s64
  s_add_u32 m0, s55, 114688
  s_nop 0
  buffer_load_dwordx4 v1, s[24:27], s56 offen lds
  s_add_u32 m0, s55, 115712
  s_nop 0
  buffer_load_dwordx4 v2, s[24:27], s56 offen lds
  s_add_u32 s56, s53, s64
  s_add_u32 m0, s55, 106496
  s_nop 0
  buffer_load_dwordx4 v1, s[28:31], s56 offen lds
  s_add_u32 m0, s55, 107520
  s_nop 0
  buffer_load_dwordx4 v2, s[28:31], s56 offen lds
  s_add_u32 s56, s53, s65
  s_add_u32 m0, s55, 90112
  s_nop 0
  buffer_load_dwordx4 v1, s[24:27], s56 offen lds
  s_add_u32 m0, s55, 91136
  s_nop 0
  buffer_load_dwordx4 v2, s[24:27], s56 offen lds
  s_add_u32 s56, s53, s65
  s_add_u32 m0, s55, 81920
  s_nop 0
  buffer_load_dwordx4 v1, s[28:31], s56 offen lds
  s_add_u32 m0, s55, 82944
  s_nop 0
  buffer_load_dwordx4 v2, s[28:31], s56 offen lds
  s_lshl_b32 s72, s5, 2
  s_and_b32 s73, s3, 3
  s_add_u32 s72, s72, s73
  s_lshl_b32 s73, s4, 6
  s_add_u32 s72, s72, s73
  s_lshl_b32 s72, s72, 10
  s_add_u32 s72, s72, 9437184
  s_add_u32 s73, s72, 32768
  v_lshlrev_b32 v12, 4, v0
  v_mov_b32 v8, -1
  v_mov_b32 v9, -1
  v_mov_b32 v10, -1
  v_mov_b32 v11, -1
  buffer_store_dwordx4 v[8:11], v12, s[16:19], s72 offen sc1
  buffer_store_dwordx4 v[8:11], v12, s[16:19], s73 offen sc1
  s_waitcnt vmcnt(10)
  s_barrier
  s_add_u32 s56, s53, s66
  s_add_u32 m0, s55, 98304
  s_nop 0
  buffer_load_dwordx4 v1, s[24:27], s56 offen lds
  s_add_u32 m0, s55, 99328
  s_nop 0
  buffer_load_dwordx4 v2, s[24:27], s56 offen lds
  s_add_u32 s56, s53, s66
  s_add_u32 m0, s55, 73728
  s_nop 0
  buffer_load_dwordx4 v1, s[28:31], s56 offen lds
  s_add_u32 m0, s55, 74752
  s_nop 0
  buffer_load_dwordx4 v2, s[28:31], s56 offen lds
  s_waitcnt vmcnt(6)
  s_barrier
  s_add_u32 s56, s53, s67
  s_add_u32 m0, s55, 122880
  s_nop 0
  buffer_load_dwordx4 v1, s[24:27], s56 offen lds
  s_add_u32 m0, s55, 123904
  s_nop 0
  buffer_load_dwordx4 v2, s[24:27], s56 offen lds
  s_add_u32 s56, s53, s67
  s_add_u32 m0, s55, 65536
  s_nop 0
  buffer_load_dwordx4 v1, s[28:31], s56 offen lds
  s_add_u32 m0, s55, 66560
  s_nop 0
  buffer_load_dwordx4 v2, s[28:31], s56 offen lds
  s_and_b32 s51, s3, 3
  s_lshr_b32 s52, s3, 2
  s_lshl_b32 s53, s5, 2
  s_add_u32 s61, s53, s51
  s_lshl_b32 s53, s61, 17
  s_add_u32 s57, s53, 1048576
  s_lshl_b32 s54, s52, 11
  s_add_u32 s53, s57, s54
  s_lshl_b32 s54, s4, 1
  s_add_u32 s54, s54, s52
  s_lshl_b32 s54, s54, 5
  s_add_u32 s61, s61, s54
  s_lshl_b32 s61, s61, 10
  s_add_u32 s61, s61, 9437184
  s_lshl_b32 s54, s4, 12
  s_mov_b32 s58, 0x0000ffff
  s_mov_b32 s59, 0x0000ffff
  s_add_u32 s56, s53, s54
  buffer_load_dwordx4 v[80:83], v160, s[16:19], s56 offen sc1
  s_add_u32 s54, s54, 4096
  s_and_b32 s54, s54, 0x1ffff
  s_mov_b64 exec, s[58:59]
  buffer_load_dwordx4 v[144:147], v161, s[16:19], s56 offen offset:1024 sc1
  buffer_load_dwordx4 v[148:151], v161, s[16:19], s56 offen offset:1536 sc1
  s_mov_b64 exec, -1
  s_cmp_eq_u32 s3, 4
  s_cbranch_scc0 Lnopoll1
  s_lshl_b32 s48, s5, 14
  s_add_u32 s48, s48, 524288
  s_add_u32 s50, s4, 0
  s_lshl_b32 s50, s50, 2
  v_add_u32 v4, s50, v0
  v_and_b32 v4, 127, v4
  v_lshlrev_b32 v4, 7, v4
  s_mov_b32 s49, 0
  s_mov_b32 exec_hi, 0
Lkvp2:
  buffer_load_dword v5, v4, s[16:19], s48 offen sc0 sc1
  s_add_u32 s49, s49, 1
  s_waitcnt vmcnt(0)
  v_cmp_ne_u32 vcc, s6, v5
  s_cmp_gt_u32 s49, 200000
  s_cbranch_scc1 Lkvpgo3
  s_cbranch_vccz Lkvpgo3
  s_sleep 1
  s_branch Lkvp2
Lkvpgo3:
  s_mov_b64 exec, -1
Lnopoll1:
  s_waitcnt vmcnt(3)
  s_barrier
  s_branch L_att_pre
L_comp:
  v_and_b32 v1, 31, v0
  v_lshrrev_b32 v2, 5, v0
  s_lshr_b32 s51, s3, 1
  s_and_b32 s52, s3, 1
  v_and_b32 v6, 3, v1
  v_lshrrev_b32 v3, 3, v1
  v_lshl_add_u32 v6, v3, 2, v6
  v_and_b32 v3, 4, v1
  v_lshl_add_u32 v6, v3, 2, v6
  s_lshl_b32 s53, s52, 5
  v_add_u32 v6, s53, v6
  v_lshrrev_b32 v3, 1, v6
  v_and_b32 v3, 7, v3
  v_xor_b32 v3, v3, v2
  v_lshlrev_b32 v3, 4, v3
  v_lshlrev_b32 v4, 7, v6
  v_xor_b32 v8, 0, v3
  v_add_u32 v8, v8, v4
  v_xor_b32 v9, 32, v3
  v_add_u32 v9, v9, v4
  v_xor_b32 v10, 64, v3
  v_add_u32 v10, v10, v4
  v_xor_b32 v11, 96, v3
  v_add_u32 v11, v11, v4
  v_bfe_u32 v3, v0, 2, 2
  v_lshrrev_b32 v4, 5, v0
  v_mul_u32_u24 v4, 8, v4
  v_add_u32 v4, v4, v3
  v_lshlrev_b32 v12, 7, v4
  v_bfe_u32 v4, v0, 4, 1
  v_lshlrev_b32 v4, 1, v4
  v_bfe_u32 v5, v0, 1, 1
  v_add_u32 v4, v4, v5
  v_mov_b32 v5, s51
  v_lshl_add_u32 v4, v5, 2, v4
  v_lshrrev_b32 v3, 1, v3
  v_lshlrev_b32 v3, 2, v3
  v_xor_b32 v4, v4, v3
  v_lshl_add_u32 v12, v4, 4, v12
  v_and_b32 v3, 1, v0
  v_lshl_add_u32 v12, v3, 3, v12
  v_add_u32 v12, 65536, v12
  v_add_u32 v13, 65536, v12
  s_lshl_b32 s53, s5, 2
  s_lshl_b32 s54, s51, 1
  s_add_u32 s53, s53, s54
  s_lshl_b32 s53, s53, 17
  s_lshl_b32 s54, s4, 12
  s_add_u32 s53, s53, s54
  s_lshl_b32 s54, s52, 11
  s_add_u32 s53, s53, s54
  s_add_u32 s53, s53, 1048576
  s_add_u32 s54, s53, 131072
  s_waitcnt lgkmcnt(0)
  s_mov_b32 s18, 33554432
  s_mov_b32 s19, 0x20000
  s_mov_b64 s[16:17], s[90:91]
  s_mov_b32 s76, 0
  v_and_b32 v14, 0x13, v1
  v_and_b32 v3, 4, v1
  v_lshl_add_u32 v14, v3, 1, v14
  v_and_b32 v3, 8, v1
  v_lshrrev_b32 v3, 1, v3
  v_add_u32 v14, v14, v3
  v_lshl_add_u32 v14, v2, 5, v14
  v_lshlrev_b32 v14, 4, v14
  v_and_b32 v15, 15, v1
  v_lshlrev_b32 v15, 4, v15
  v_lshl_add_u32 v15, v2, 8, v15
  v_lshrrev_b32 v3, 4, v1
  v_lshl_add_u32 v15, v3, 17, v15
  s_mul_i32 s74, s51, 6144
  s_lshl_b32 s75, s52, 10
  s_add_u32 s74, s74, s75
  s_add_u32 s74, s74, 131072
  v_lshlrev_b32 v7, 4, v0
  v_add_u32 v7, s74, v7
  s_mov_b32 s75, 1052289595
  s_load_dword s6, s[16:17], 0
  v_lshlrev_b32 v160, 4, v0
  v_and_b32 v161, 15, v0
  v_lshlrev_b32 v161, 4, v161
  v_lshrrev_b32 v162, 5, v0
  v_lshl_add_u32 v161, v162, 8, v161
  s_mul_i32 s70, s3, 3072
  s_add_u32 s70, s70, 131072
  v_add_u32 v165, s70, v161
  v_mov_b32 v112, 0
  v_mov_b32 v113, 0
  v_mov_b32 v114, 0
  v_mov_b32 v115, 0
  v_mov_b32 v116, 0
  v_mov_b32 v117, 0
  v_mov_b32 v118, 0
  v_mov_b32 v119, 0
  v_mov_b32 v120, 0
  v_mov_b32 v121, 0
  v_mov_b32 v122, 0
  v_mov_b32 v123, 0
  v_mov_b32 v124, 0
  v_mov_b32 v125, 0
  v_mov_b32 v126, 0
  v_mov_b32 v127, 0
  v_mov_b32 v128, 0
  v_mov_b32 v129, 0
  v_mov_b32 v130, 0
  v_mov_b32 v131, 0
  v_mov_b32 v132, 0
  v_mov_b32 v133, 0
  v_mov_b32 v134, 0
  v_mov_b32 v135, 0
  v_mov_b32 v136, 0
  v_mov_b32 v137, 0
  v_mov_b32 v138, 0
  v_mov_b32 v139, 0
  v_mov_b32 v140, 0
  v_mov_b32 v141, 0
  v_mov_b32 v142, 0
  v_mov_b32 v143, 0
  v_and_b32 v162, 27, v0
  v_cmp_eq_u32 vcc, 16, v162
  v_mov_b32 v163, 0x3f803f80
  v_mov_b32 v164, 0xdddddddd
  v_cndmask_b32 v163, 0, v163, vcc
  v_mov_b32 v144, v163
  v_mov_b32 v145, v163
  v_mov_b32 v146, v163
  v_mov_b32 v147, v163
  v_mov_b32 v148, v163
  v_mov_b32 v149, v163
  v_mov_b32 v150, v163
  v_mov_b32 v151, v163
  v_mov_b32 v152, v163
  v_mov_b32 v153, v163
  v_mov_b32 v154, v163
  v_mov_b32 v155, v163
  v_mov_b32 v156, v163
  v_mov_b32 v157, v163
  v_mov_b32 v158, v163
  v_mov_b32 v159, v163
  s_barrier
  ds_read_b128 v[64:67], v8 offset:0
  ds_read_b64_tr_b16 v[68:69], v12 offset:0
  ds_read_b64_tr_b16 v[70:71], v12 offset:512
  ds_read_b64_tr_b16 v[72:73], v12 offset:8192
  ds_read_b64_tr_b16 v[74:75], v12 offset:8704
  ds_read_b128 v[80:83], v9 offset:0
  ds_read_b64_tr_b16 v[84:85], v12 offset:2048
  ds_read_b64_tr_b16 v[86:87], v12 offset:2560
  ds_read_b64_tr_b16 v[88:89], v12 offset:10240
  ds_read_b64_tr_b16 v[90:91], v12 offset:10752
  ds_read_b128 v[96:99], v10 offset:0
  ds_read_b64_tr_b16 v[100:101], v12 offset:4096
  ds_read_b64_tr_b16 v[102:103], v12 offset:4608
  ds_read_b64_tr_b16 v[104:105], v12 offset:12288
  ds_read_b64_tr_b16 v[106:107], v12 offset:12800
  s_waitcnt lgkmcnt(10)
  v_mfma_f32_32x32x16_bf16 v[16:31], v[68:71], v[64:67], 0
  v_mfma_f32_32x32x16_bf16 v[32:47], v[64:67], v[72:75], 0
  ds_read_b128 v[64:67], v11 offset:0
  ds_read_b64_tr_b16 v[68:69], v12 offset:6144
  ds_read_b64_tr_b16 v[70:71], v12 offset:6656
  ds_read_b64_tr_b16 v[72:73], v12 offset:14336
  ds_read_b64_tr_b16 v[74:75], v12 offset:14848
  s_waitcnt lgkmcnt(10)
  v_mfma_f32_32x32x16_bf16 v[16:31], v[84:87], v[80:83], v[16:31]
  v_mfma_f32_32x32x16_bf16 v[32:47], v[80:83], v[88:91], v[32:47]
  s_waitcnt lgkmcnt(0)
  s_barrier
  ds_read_b128 v[80:83], v8 offset:8192
  ds_read_b64_tr_b16 v[84:85], v12 offset:16384
  ds_read_b64_tr_b16 v[86:87], v12 offset:16896
  ds_read_b64_tr_b16 v[88:89], v12 offset:24576
  ds_read_b64_tr_b16 v[90:91], v12 offset:25088
  v_mfma_f32_32x32x16_bf16 v[16:31], v[100:103], v[96:99], v[16:31]
  v_mfma_f32_32x32x16_bf16 v[32:47], v[96:99], v[104:107], v[32:47]
  ds_read_b128 v[96:99], v9 offset:8192
  ds_read_b64_tr_b16 v[100:101], v12 offset:18432
  ds_read_b64_tr_b16 v[102:103], v12 offset:18944
  ds_read_b64_tr_b16 v[104:105], v12 offset:26624
  ds_read_b64_tr_b16 v[106:107], v12 offset:27136
  v_mfma_f32_32x32x16_bf16 v[16:31], v[68:71], v[64:67], v[16:31]
  v_mfma_f32_32x32x16_bf16 v[32:47], v[64:67], v[72:75], v[32:47]
  ds_read_b128 v[64:67], v10 offset:8192
  ds_read_b64_tr_b16 v[68:69], v12 offset:20480
  ds_read_b64_tr_b16 v[70:71], v12 offset:20992
  ds_read_b64_tr_b16 v[72:73], v12 offset:28672
  ds_read_b64_tr_b16 v[74:75], v12 offset:29184
  s_waitcnt lgkmcnt(10)
  v_mfma_f32_32x32x16_bf16 v[16:31], v[84:87], v[80:83], v[16:31]
  v_mfma_f32_32x32x16_bf16 v[32:47], v[80:83], v[88:91], v[32:47]
  ds_read_b128 v[80:83], v11 offset:8192
  ds_read_b64_tr_b16 v[84:85], v12 offset:22528
  ds_read_b64_tr_b16 v[86:87], v12 offset:23040
  ds_read_b64_tr_b16 v[88:89], v12 offset:30720
  ds_read_b64_tr_b16 v[90:91], v12 offset:31232
  s_waitcnt lgkmcnt(10)
  v_mfma_f32_32x32x16_bf16 v[16:31], v[100:103], v[96:99], v[16:31]
  v_mfma_f32_32x32x16_bf16 v[32:47], v[96:99], v[104:107], v[32:47]
  s_waitcnt lgkmcnt(0)
  s_barrier
  ds_read_b128 v[96:99], v8 offset:16384
  ds_read_b64_tr_b16 v[100:101], v12 offset:32768
  ds_read_b64_tr_b16 v[102:103], v12 offset:33280
  ds_read_b64_tr_b16 v[104:105], v13 offset:0
  ds_read_b64_tr_b16 v[106:107], v13 offset:512
  v_mfma_f32_32x32x16_bf16 v[16:31], v[68:71], v[64:67], v[16:31]
  v_mfma_f32_32x32x16_bf16 v[32:47], v[64:67], v[72:75], v[32:47]
  ds_read_b128 v[64:67], v9 offset:16384
  ds_read_b64_tr_b16 v[68:69], v12 offset:34816
  ds_read_b64_tr_b16 v[70:71], v12 offset:35328
  ds_read_b64_tr_b16 v[72:73], v13 offset:2048
  ds_read_b64_tr_b16 v[74:75], v13 offset:2560
  v_mfma_f32_32x32x16_bf16 v[16:31], v[84:87], v[80:83], v[16:31]
  v_mfma_f32_32x32x16_bf16 v[32:47], v[80:83], v[88:91], v[32:47]
  ds_read_b128 v[80:83], v10 offset:16384
  ds_read_b64_tr_b16 v[84:85], v12 offset:36864
  ds_read_b64_tr_b16 v[86:87], v12 offset:37376
  ds_read_b64_tr_b16 v[88:89], v13 offset:4096
  ds_read_b64_tr_b16 v[90:91], v13 offset:4608
  s_waitcnt lgkmcnt(10)
  v_mfma_f32_32x32x16_bf16 v[16:31], v[100:103], v[96:99], v[16:31]
  v_mfma_f32_32x32x16_bf16 v[32:47], v[96:99], v[104:107], v[32:47]
  ds_read_b128 v[96:99], v11 offset:16384
  ds_read_b64_tr_b16 v[100:101], v12 offset:38912
  ds_read_b64_tr_b16 v[102:103], v12 offset:39424
  ds_read_b64_tr_b16 v[104:105], v13 offset:6144
  ds_read_b64_tr_b16 v[106:107], v13 offset:6656
  s_waitcnt lgkmcnt(10)
  v_mfma_f32_32x32x16_bf16 v[16:31], v[68:71], v[64:67], v[16:31]
  v_mfma_f32_32x32x16_bf16 v[32:47], v[64:67], v[72:75], v[32:47]
  s_waitcnt lgkmcnt(0)
  s_barrier
  ds_read_b128 v[64:67], v8 offset:24576
  ds_read_b64_tr_b16 v[68:69], v13 offset:8192
  ds_read_b64_tr_b16 v[70:71], v13 offset:8704
  ds_read_b64_tr_b16 v[72:73], v13 offset:16384
  ds_read_b64_tr_b16 v[74:75], v13 offset:16896
  v_mfma_f32_32x32x16_bf16 v[16:31], v[84:87], v[80:83], v[16:31]
  v_mfma_f32_32x32x16_bf16 v[32:47], v[80:83], v[88:91], v[32:47]
  ds_read_b128 v[80:83], v9 offset:24576
  ds_read_b64_tr_b16 v[84:85], v13 offset:10240
  ds_read_b64_tr_b16 v[86:87], v13 offset:10752
  ds_read_b64_tr_b16 v[88:89], v13 offset:18432
  ds_read_b64_tr_b16 v[90:91], v13 offset:18944
  v_mfma_f32_32x32x16_bf16 v[16:31], v[100:103], v[96:99], v[16:31]
  v_mfma_f32_32x32x16_bf16 v[32:47], v[96:99], v[104:107], v[32:47]
  ds_read_b128 v[96:99], v10 offset:24576
  ds_read_b64_tr_b16 v[100:101], v13 offset:12288
  ds_read_b64_tr_b16 v[102:103], v13 offset:12800
  ds_read_b64_tr_b16 v[104:105], v13 offset:20480
  ds_read_b64_tr_b16 v[106:107], v13 offset:20992
  s_waitcnt lgkmcnt(10)
  v_mfma_f32_32x32x16_bf16 v[16:31], v[68:71], v[64:67], v[16:31]
  v_mfma_f32_32x32x16_bf16 v[32:47], v[64:67], v[72:75], v[32:47]
  ds_read_b128 v[64:67], v11 offset:24576
  ds_read_b64_tr_b16 v[68:69], v13 offset:14336
  ds_read_b64_tr_b16 v[70:71], v13 offset:14848
  ds_read_b64_tr_b16 v[72:73], v13 offset:22528
  ds_read_b64_tr_b16 v[74:75], v13 offset:23040
  s_waitcnt lgkmcnt(10)
  v_mfma_f32_32x32x16_bf16 v[16:31], v[84:87], v[80:83], v[16:31]
  v_mfma_f32_32x32x16_bf16 v[32:47], v[80:83], v[88:91], v[32:47]
  s_waitcnt lgkmcnt(0)
  s_barrier
  ds_read_b128 v[80:83], v8 offset:32768
  ds_read_b64_tr_b16 v[84:85], v12 offset:0
  ds_read_b64_tr_b16 v[86:87], v12 offset:512
  ds_read_b64_tr_b16 v[88:89], v12 offset:8192
  ds_read_b64_tr_b16 v[90:91], v12 offset:8704
  v_mfma_f32_32x32x16_bf16 v[16:31], v[100:103], v[96:99], v[16:31]
  v_mfma_f32_32x32x16_bf16 v[32:47], v[96:99], v[104:107], v[32:47]
  ds_read_b128 v[96:99], v9 offset:32768
  ds_read_b64_tr_b16 v[100:101], v12 offset:2048
  ds_read_b64_tr_b16 v[102:103], v12 offset:2560
  ds_read_b64_tr_b16 v[104:105], v12 offset:10240
  ds_read_b64_tr_b16 v[106:107], v12 offset:10752
  v_mfma_f32_32x32x16_bf16 v[16:31], v[68:71], v[64:67], v[16:31]
  v_mfma_f32_32x32x16_bf16 v[32:47], v[64:67], v[72:75], v[32:47]
  ds_read_b128 v[64:67], v10 offset:32768
  ds_read_b64_tr_b16 v[68:69], v12 offset:4096
  ds_read_b64_tr_b16 v[70:71], v12 offset:4608
  ds_read_b64_tr_b16 v[72:73], v12 offset:12288
  ds_read_b64_tr_b16 v[74:75], v12 offset:12800
  s_waitcnt lgkmcnt(10)
  v_mfma_f32_32x32x16_bf16 v[16:31], v[84:87], v[80:83], v[16:31]
  v_mfma_f32_32x32x16_bf16 v[32:47], v[80:83], v[88:91], v[32:47]
  ds_read_b128 v[80:83], v11 offset:32768
  ds_read_b64_tr_b16 v[84:85], v12 offset:6144
  ds_read_b64_tr_b16 v[86:87], v12 offset:6656
  ds_read_b64_tr_b16 v[88:89], v12 offset:14336
  ds_read_b64_tr_b16 v[90:91], v12 offset:14848
  s_waitcnt lgkmcnt(10)
  v_mfma_f32_32x32x16_bf16 v[16:31], v[100:103], v[96:99], v[16:31]
  v_mfma_f32_32x32x16_bf16 v[32:47], v[96:99], v[104:107], v[32:47]
  s_waitcnt lgkmcnt(0)
  s_barrier
  ds_read_b128 v[96:99], v8 offset:40960
  ds_read_b64_tr_b16 v[100:101], v12 offset:16384
  ds_read_b64_tr_b16 v[102:103], v12 offset:16896
  ds_read_b64_tr_b16 v[104:105], v12 offset:24576
  ds_read_b64_tr_b16 v[106:107], v12 offset:25088
  v_mfma_f32_32x32x16_bf16 v[16:31], v[68:71], v[64:67], v[16:31]
  v_mfma_f32_32x32x16_bf16 v[32:47], v[64:67], v[72:75], v[32:47]
  ds_read_b128 v[64:67], v9 offset:40960
  ds_read_b64_tr_b16 v[68:69], v12 offset:18432
  ds_read_b64_tr_b16 v[70:71], v12 offset:18944
  ds_read_b64_tr_b16 v[72:73], v12 offset:26624
  ds_read_b64_tr_b16 v[74:75], v12 offset:27136
  v_mfma_f32_32x32x16_bf16 v[16:31], v[84:87], v[80:83], v[16:31]
  v_mfma_f32_32x32x16_bf16 v[32:47], v[80:83], v[88:91], v[32:47]
  ds_read_b128 v[80:83], v10 offset:40960
  ds_read_b64_tr_b16 v[84:85], v12 offset:20480
  ds_read_b64_tr_b16 v[86:87], v12 offset:20992
  ds_read_b64_tr_b16 v[88:89], v12 offset:28672
  ds_read_b64_tr_b16 v[90:91], v12 offset:29184
  s_waitcnt lgkmcnt(10)
  v_mfma_f32_32x32x16_bf16 v[16:31], v[100:103], v[96:99], v[16:31]
  v_mfma_f32_32x32x16_bf16 v[32:47], v[96:99], v[104:107], v[32:47]
  ds_read_b128 v[96:99], v11 offset:40960
  ds_read_b64_tr_b16 v[100:101], v12 offset:22528
  ds_read_b64_tr_b16 v[102:103], v12 offset:23040
  ds_read_b64_tr_b16 v[104:105], v12 offset:30720
  ds_read_b64_tr_b16 v[106:107], v12 offset:31232
  s_waitcnt lgkmcnt(10)
  v_mfma_f32_32x32x16_bf16 v[16:31], v[68:71], v[64:67], v[16:31]
  v_mfma_f32_32x32x16_bf16 v[32:47], v[64:67], v[72:75], v[32:47]
  s_waitcnt lgkmcnt(0)
  s_barrier
  ds_read_b128 v[64:67], v8 offset:49152
  ds_read_b64_tr_b16 v[68:69], v12 offset:32768
  ds_read_b64_tr_b16 v[70:71], v12 offset:33280
  ds_read_b64_tr_b16 v[72:73], v13 offset:0
  ds_read_b64_tr_b16 v[74:75], v13 offset:512
  v_mfma_f32_32x32x16_bf16 v[16:31], v[84:87], v[80:83], v[16:31]
  v_mfma_f32_32x32x16_bf16 v[32:47], v[80:83], v[88:91], v[32:47]
  ds_read_b128 v[80:83], v9 offset:49152
  ds_read_b64_tr_b16 v[84:85], v12 offset:34816
  ds_read_b64_tr_b16 v[86:87], v12 offset:35328
  ds_read_b64_tr_b16 v[88:89], v13 offset:2048
  ds_read_b64_tr_b16 v[90:91], v13 offset:2560
  v_mfma_f32_32x32x16_bf16 v[16:31], v[100:103], v[96:99], v[16:31]
  v_mfma_f32_32x32x16_bf16 v[32:47], v[96:99], v[104:107], v[32:47]
  ds_read_b128 v[96:99], v10 offset:49152
  ds_read_b64_tr_b16 v[100:101], v12 offset:36864
  ds_read_b64_tr_b16 v[102:103], v12 offset:37376
  ds_read_b64_tr_b16 v[104:105], v13 offset:4096
  ds_read_b64_tr_b16 v[106:107], v13 offset:4608
  s_waitcnt lgkmcnt(10)
  v_mfma_f32_32x32x16_bf16 v[16:31], v[68:71], v[64:67], v[16:31]
  v_mfma_f32_32x32x16_bf16 v[32:47], v[64:67], v[72:75], v[32:47]
  ds_read_b128 v[64:67], v11 offset:49152
  ds_read_b64_tr_b16 v[68:69], v12 offset:38912
  ds_read_b64_tr_b16 v[70:71], v12 offset:39424
  ds_read_b64_tr_b16 v[72:73], v13 offset:6144
  ds_read_b64_tr_b16 v[74:75], v13 offset:6656
  s_waitcnt lgkmcnt(10)
  v_mfma_f32_32x32x16_bf16 v[16:31], v[84:87], v[80:83], v[16:31]
  v_mfma_f32_32x32x16_bf16 v[32:47], v[80:83], v[88:91], v[32:47]
  s_waitcnt lgkmcnt(0)
  s_barrier
  s_setprio 3
  ds_read_b128 v[80:83], v8 offset:57344
  ds_read_b64_tr_b16 v[84:85], v13 offset:8192
  ds_read_b64_tr_b16 v[86:87], v13 offset:8704
  ds_read_b64_tr_b16 v[88:89], v13 offset:16384
  ds_read_b64_tr_b16 v[90:91], v13 offset:16896
  v_mfma_f32_32x32x16_bf16 v[16:31], v[100:103], v[96:99], v[16:31]
  v_mfma_f32_32x32x16_bf16 v[32:47], v[96:99], v[104:107], v[32:47]
  ds_read_b128 v[96:99], v9 offset:57344
  ds_read_b64_tr_b16 v[100:101], v13 offset:10240
  ds_read_b64_tr_b16 v[102:103], v13 offset:10752
  ds_read_b64_tr_b16 v[104:105], v13 offset:18432
  ds_read_b64_tr_b16 v[106:107], v13 offset:18944
  v_mfma_f32_32x32x16_bf16 v[16:31], v[68:71], v[64:67], v[16:31]
  v_mfma_f32_32x32x16_bf16 v[32:47], v[64:67], v[72:75], v[32:47]
  ds_read_b128 v[64:67], v10 offset:57344
  ds_read_b64_tr_b16 v[68:69], v13 offset:12288
  ds_read_b64_tr_b16 v[70:71], v13 offset:12800
  ds_read_b64_tr_b16 v[72:73], v13 offset:20480
  ds_read_b64_tr_b16 v[74:75], v13 offset:20992
  s_waitcnt lgkmcnt(10)
  v_mfma_f32_32x32x16_bf16 v[16:31], v[84:87], v[80:83], v[16:31]
  v_mfma_f32_32x32x16_bf16 v[32:47], v[80:83], v[88:91], v[32:47]
  ds_read_b128 v[80:83], v11 offset:57344
  ds_read_b64_tr_b16 v[84:85], v13 offset:14336
  ds_read_b64_tr_b16 v[86:87], v13 offset:14848
  ds_read_b64_tr_b16 v[88:89], v13 offset:22528
  ds_read_b64_tr_b16 v[90:91], v13 offset:23040
  s_waitcnt lgkmcnt(10)
  v_mfma_f32_32x32x16_bf16 v[16:31], v[100:103], v[96:99], v[16:31]
  v_mfma_f32_32x32x16_bf16 v[32:47], v[96:99], v[104:107], v[32:47]
  s_waitcnt lgkmcnt(5)
  v_mfma_f32_32x32x16_bf16 v[16:31], v[68:71], v[64:67], v[16:31]
  v_mfma_f32_32x32x16_bf16 v[32:47], v[64:67], v[72:75], v[32:47]
  s_waitcnt lgkmcnt(0)
  v_mfma_f32_32x32x16_bf16 v[16:31], v[84:87], v[80:83], v[16:31]
  v_mfma_f32_32x32x16_bf16 v[32:47], v[80:83], v[88:91], v[32:47]
  s_nop 10
  v_cvt_pk_bf16_f32 v48, v16, v17
  v_cvt_pk_bf16_f32 v49, v18, v19
  v_cvt_pk_bf16_f32 v50, v20, v21
  v_cvt_pk_bf16_f32 v51, v22, v23
  buffer_store_dwordx4 v[48:51], v14, s[16:19], s53 offen sc1
  v_cvt_pk_bf16_f32 v52, v24, v25
  v_cvt_pk_bf16_f32 v53, v26, v27
  v_cvt_pk_bf16_f32 v54, v28, v29
  v_cvt_pk_bf16_f32 v55, v30, v31
  buffer_store_dwordx4 v[52:55], v14, s[16:19], s54 offen sc1
  v_cvt_pk_bf16_f32 v56, v32, v33
  v_cvt_pk_bf16_f32 v57, v34, v35
  v_cvt_pk_bf16_f32 v58, v36, v37
  v_cvt_pk_bf16_f32 v59, v38, v39
  buffer_store_dwordx4 v[56:59], v15, s[16:19], s53 offen offset:1024 sc1
  v_cvt_pk_bf16_f32 v60, v40, v41
  v_cvt_pk_bf16_f32 v61, v42, v43
  v_cvt_pk_bf16_f32 v62, v44, v45
  v_cvt_pk_bf16_f32 v63, v46, v47
  buffer_store_dwordx4 v[60:63], v15, s[16:19], s53 offen offset:1536 sc1
  s_setprio 0
  s_barrier
  s_mul_i32 s6, s6, 0x9E3779B1
  s_add_u32 s6, s6, 0x7F4A7C15
  s_lshl_b32 s48, s5, 5
  s_add_u32 s48, s48, s4
  s_lshl_b32 s48, s48, 2
  s_add_u32 s48, s48, s3
  s_lshl_b32 s48, s48, 7
  s_add_u32 s48, s48, 524288
  v_mov_b32 v16, s48
  v_mov_b32 v17, s6
  ds_read_b128 v[64:67], v8 offset:0
  ds_read_b64_tr_b16 v[68:69], v12 offset:40960
  ds_read_b64_tr_b16 v[70:71], v12 offset:41472
  ds_read_b128 v[80:83], v9 offset:0
  ds_read_b64_tr_b16 v[84:85], v12 offset:43008
  ds_read_b64_tr_b16 v[86:87], v12 offset:43520
  ds_read_b128 v[96:99], v10 offset:0
  ds_read_b64_tr_b16 v[100:101], v12 offset:45056
  ds_read_b64_tr_b16 v[102:103], v12 offset:45568
  s_waitcnt lgkmcnt(6)
  v_mfma_f32_32x32x16_bf16 v[48:63], v[68:71], v[64:67], 0
  ds_read_b128 v[64:67], v11 offset:0
  ds_read_b64_tr_b16 v[68:69], v12 offset:47104
  ds_read_b64_tr_b16 v[70:71], v12 offset:47616
  s_waitcnt lgkmcnt(6)
  v_mfma_f32_32x32x16_bf16 v[48:63], v[84:87], v[80:83], v[48:63]
  ds_read_b128 v[80:83], v8 offset:8192
  ds_read_b64_tr_b16 v[84:85], v12 offset:57344
  ds_read_b64_tr_b16 v[86:87], v12 offset:57856
  s_waitcnt lgkmcnt(6)
  v_mfma_f32_32x32x16_bf16 v[48:63], v[100:103], v[96:99], v[48:63]
  ds_read_b128 v[96:99], v9 offset:8192
  ds_read_b64_tr_b16 v[100:101], v12 offset:59392
  ds_read_b64_tr_b16 v[102:103], v12 offset:59904
  s_waitcnt lgkmcnt(6)
  v_mfma_f32_32x32x16_bf16 v[48:63], v[68:71], v[64:67], v[48:63]
  s_cmp_eq_u32 s76, 0
  s_cbranch_scc0 Lpub4
  s_getreg_b32 s77, hwreg(HW_REG_IB_STS)
  s_and_b32 s77, s77, 0xc0000f
  s_cbranch_scc1 Lpub4
  s_waitcnt vmcnt(0)
  s_setprio 3
  s_mov_b64 exec, 1
  buffer_store_dword v17, v16, s[16:19], 0 offen sc1
  s_mov_b64 exec, -1
  s_setprio 0
  s_mov_b32 s76, 1
Lpub4:
  ds_read_b128 v[64:67], v10 offset:8192
  ds_read_b64_tr_b16 v[68:69], v12 offset:61440
  ds_read_b64_tr_b16 v[70:71], v12 offset:61952
  s_waitcnt lgkmcnt(6)
  v_mfma_f32_32x32x16_bf16 v[48:63], v[84:87], v[80:83], v[48:63]
  ds_read_b128 v[80:83], v11 offset:8192
  ds_read_b64_tr_b16 v[84:85], v12 offset:63488
  ds_read_b64_tr_b16 v[86:87], v12 offset:64000
  s_waitcnt lgkmcnt(6)
  v_mfma_f32_32x32x16_bf16 v[48:63], v[100:103], v[96:99], v[48:63]
  s_cmp_eq_u32 s76, 0
  s_cbranch_scc0 Lpub5
  s_getreg_b32 s77, hwreg(HW_REG_IB_STS)
  s_and_b32 s77, s77, 0xc0000f
  s_cbranch_scc1 Lpub5
  s_waitcnt vmcnt(0)
  s_setprio 3
  s_mov_b64 exec, 1
  buffer_store_dword v17, v16, s[16:19], 0 offen sc1
  s_mov_b64 exec, -1
  s_setprio 0
  s_mov_b32 s76, 1
Lpub5:
  ds_read_b128 v[96:99], v8 offset:16384
  ds_read_b64_tr_b16 v[100:101], v12 offset:49152
  ds_read_b64_tr_b16 v[102:103], v12 offset:49664
  s_waitcnt lgkmcnt(6)
  v_mfma_f32_32x32x16_bf16 v[48:63], v[68:71], v[64:67], v[48:63]
  ds_read_b128 v[64:67], v9 offset:16384
  ds_read_b64_tr_b16 v[68:69], v12 offset:51200
  ds_read_b64_tr_b16 v[70:71], v12 offset:51712
  s_waitcnt lgkmcnt(6)
  v_mfma_f32_32x32x16_bf16 v[48:63], v[84:87], v[80:83], v[48:63]
  s_cmp_eq_u32 s76, 0
  s_cbranch_scc0 Lpub6
  s_getreg_b32 s77, hwreg(HW_REG_IB_STS)
  s_and_b32 s77, s77, 0xc0000f
  s_cbranch_scc1 Lpub6
  s_waitcnt vmcnt(0)
  s_setprio 3
  s_mov_b64 exec, 1
  buffer_store_dword v17, v16, s[16:19], 0 offen sc1
  s_mov_b64 exec, -1
  s_setprio 0
  s_mov_b32 s76, 1
Lpub6:
  ds_read_b128 v[80:83], v10 offset:16384
  ds_read_b64_tr_b16 v[84:85], v12 offset:53248
  ds_read_b64_tr_b16 v[86:87], v12 offset:53760
  s_waitcnt lgkmcnt(6)
  v_mfma_f32_32x32x16_bf16 v[48:63], v[100:103], v[96:99], v[48:63]
  ds_read_b128 v[96:99], v11 offset:16384
  ds_read_b64_tr_b16 v[100:101], v12 offset:55296
  ds_read_b64_tr_b16 v[102:103], v12 offset:55808
  s_waitcnt lgkmcnt(6)
  v_mfma_f32_32x32x16_bf16 v[48:63], v[68:71], v[64:67], v[48:63]
  s_cmp_eq_u32 s76, 0
  s_cbranch_scc0 Lpub7
  s_getreg_b32 s77, hwreg(HW_REG_IB_STS)
  s_and_b32 s77, s77, 0xc0000f
  s_cbranch_scc1 Lpub7
  s_waitcnt vmcnt(0)
  s_setprio 3
  s_mov_b64 exec, 1
  buffer_store_dword v17, v16, s[16:19], 0 offen sc1
  s_mov_b64 exec, -1
  s_setprio 0
  s_mov_b32 s76, 1
Lpub7:
  v_lshlrev_b32 v24, 2, v0
  v_add_u32 v24, 161792, v24
  ds_read_b32 v20, v24
  ds_read_b32 v21, v24 offset:256
  ds_read_b32 v22, v24 offset:512
  ds_read_b32 v23, v24 offset:768
  s_waitcnt lgkmcnt(0)
  s_cmp_eq_u32 s76, 0
  s_cbranch_scc0 Lpub8
  s_getreg_b32 s77, hwreg(HW_REG_IB_STS)
  s_and_b32 s77, s77, 0xc0000f
  s_cbranch_scc1 Lpub8
  s_waitcnt vmcnt(0)
  s_setprio 3
  s_mov_b64 exec, 1
  buffer_store_dword v17, v16, s[16:19], 0 offen sc1
  s_mov_b64 exec, -1
  s_setprio 0
  s_mov_b32 s76, 1
Lpub8:
  s_barrier
  s_waitcnt lgkmcnt(0)
  v_add_f32 v20, v20, v21
  v_add_f32 v22, v22, v23
  v_add_f32 v20, v20, v22
  v_cvt_pk_bf16_f32 v20, v20, v20
  v_and_b32 v20, 0xffff0000, v20
  v_mul_f32 v20, 3216550459, v20
  v_exp_f32 v20, v20
  s_nop 0
  v_add_f32 v20, 1.0, v20
  v_rcp_f32 v20, v20
  s_nop 0
  v_cvt_pk_bf16_f32 v20, v20, v20
  v_and_b32 v20, 0xffff0000, v20
  ds_write_b32 v24, v20 offset:1024
  ds_read_b128 v[64:67], v8 offset:24576
  ds_read_b64_tr_b16 v[68:69], v13 offset:0
  ds_read_b64_tr_b16 v[70:71], v13 offset:512
  v_mfma_f32_32x32x16_bf16 v[48:63], v[84:87], v[80:83], v[48:63]
  ds_read_b128 v[80:83], v9 offset:24576
  ds_read_b64_tr_b16 v[84:85], v13 offset:2048
  ds_read_b64_tr_b16 v[86:87], v13 offset:2560
  v_mfma_f32_32x32x16_bf16 v[48:63], v[100:103], v[96:99], v[48:63]
  s_cmp_eq_u32 s76, 0
  s_cbranch_scc0 Lpub9
  s_getreg_b32 s77, hwreg(HW_REG_IB_STS)
  s_and_b32 s77, s77, 0xc0000f
  s_cbranch_scc1 Lpub9
  s_waitcnt vmcnt(0)
  s_setprio 3
  s_mov_b64 exec, 1
  buffer_store_dword v17, v16, s[16:19], 0 offen sc1
  s_mov_b64 exec, -1
  s_setprio 0
  s_mov_b32 s76, 1
Lpub9:
  ds_read_b128 v[96:99], v10 offset:24576
  ds_read_b64_tr_b16 v[100:101], v13 offset:4096
  ds_read_b64_tr_b16 v[102:103], v13 offset:4608
  s_waitcnt lgkmcnt(6)
  v_mfma_f32_32x32x16_bf16 v[48:63], v[68:71], v[64:67], v[48:63]
  ds_read_b128 v[64:67], v11 offset:24576
  ds_read_b64_tr_b16 v[68:69], v13 offset:6144
  ds_read_b64_tr_b16 v[70:71], v13 offset:6656
  s_waitcnt lgkmcnt(6)
  v_mfma_f32_32x32x16_bf16 v[48:63], v[84:87], v[80:83], v[48:63]
  s_cmp_eq_u32 s76, 0
  s_cbranch_scc0 Lpub10
  s_getreg_b32 s77, hwreg(HW_REG_IB_STS)
  s_and_b32 s77, s77, 0xc0000f
  s_cbranch_scc1 Lpub10
  s_waitcnt vmcnt(0)
  s_setprio 3
  s_mov_b64 exec, 1
  buffer_store_dword v17, v16, s[16:19], 0 offen sc1
  s_mov_b64 exec, -1
  s_setprio 0
  s_mov_b32 s76, 1
Lpub10:
  ds_read_b128 v[80:83], v8 offset:32768
  ds_read_b64_tr_b16 v[84:85], v12 offset:32768
  ds_read_b64_tr_b16 v[86:87], v12 offset:33280
  s_waitcnt lgkmcnt(6)
  v_mfma_f32_32x32x16_bf16 v[48:63], v[100:103], v[96:99], v[48:63]
  ds_read_b128 v[96:99], v9 offset:32768
  ds_read_b64_tr_b16 v[100:101], v12 offset:34816
  ds_read_b64_tr_b16 v[102:103], v12 offset:35328
  s_waitcnt lgkmcnt(6)
  v_mfma_f32_32x32x16_bf16 v[48:63], v[68:71], v[64:67], v[48:63]
  s_cmp_eq_u32 s76, 0
  s_cbranch_scc0 Lpub11
  s_getreg_b32 s77, hwreg(HW_REG_IB_STS)
  s_and_b32 s77, s77, 0xc0000f
  s_cbranch_scc1 Lpub11
  s_waitcnt vmcnt(0)
  s_setprio 3
  s_mov_b64 exec, 1
  buffer_store_dword v17, v16, s[16:19], 0 offen sc1
  s_mov_b64 exec, -1
  s_setprio 0
  s_mov_b32 s76, 1
Lpub11:
  ds_read_b128 v[64:67], v10 offset:32768
  ds_read_b64_tr_b16 v[68:69], v12 offset:36864
  ds_read_b64_tr_b16 v[70:71], v12 offset:37376
  s_waitcnt lgkmcnt(6)
  v_mfma_f32_32x32x16_bf16 v[48:63], v[84:87], v[80:83], v[48:63]
  ds_read_b128 v[80:83], v11 offset:32768
  ds_read_b64_tr_b16 v[84:85], v12 offset:38912
  ds_read_b64_tr_b16 v[86:87], v12 offset:39424
  s_waitcnt lgkmcnt(6)
  v_mfma_f32_32x32x16_bf16 v[48:63], v[100:103], v[96:99], v[48:63]
  s_cmp_eq_u32 s76, 0
  s_cbranch_scc0 Lpub12
  s_getreg_b32 s77, hwreg(HW_REG_IB_STS)
  s_and_b32 s77, s77, 0xc0000f
  s_cbranch_scc1 Lpub12
  s_waitcnt vmcnt(0)
  s_setprio 3
  s_mov_b64 exec, 1
  buffer_store_dword v17, v16, s[16:19], 0 offen sc1
  s_mov_b64 exec, -1
  s_setprio 0
  s_mov_b32 s76, 1
Lpub12:
  ds_read_b128 v[96:99], v8 offset:40960
  ds_read_b64_tr_b16 v[100:101], v13 offset:16384
  ds_read_b64_tr_b16 v[102:103], v13 offset:16896
  s_waitcnt lgkmcnt(6)
  v_mfma_f32_32x32x16_bf16 v[48:63], v[68:71], v[64:67], v[48:63]
  ds_read_b128 v[64:67], v9 offset:40960
  ds_read_b64_tr_b16 v[68:69], v13 offset:18432
  ds_read_b64_tr_b16 v[70:71], v13 offset:18944
  s_waitcnt lgkmcnt(6)
  v_mfma_f32_32x32x16_bf16 v[48:63], v[84:87], v[80:83], v[48:63]
  s_cmp_eq_u32 s76, 0
  s_cbranch_scc0 Lpub13
  s_getreg_b32 s77, hwreg(HW_REG_IB_STS)
  s_and_b32 s77, s77, 0xc0000f
  s_cbranch_scc1 Lpub13
  s_waitcnt vmcnt(0)
  s_setprio 3
  s_mov_b64 exec, 1
  buffer_store_dword v17, v16, s[16:19], 0 offen sc1
  s_mov_b64 exec, -1
  s_setprio 0
  s_mov_b32 s76, 1
Lpub13:
  ds_read_b128 v[80:83], v10 offset:40960
  ds_read_b64_tr_b16 v[84:85], v13 offset:20480
  ds_read_b64_tr_b16 v[86:87], v13 offset:20992
  s_waitcnt lgkmcnt(6)
  v_mfma_f32_32x32x16_bf16 v[48:63], v[100:103], v[96:99], v[48:63]
  ds_read_b128 v[96:99], v11 offset:40960
  ds_read_b64_tr_b16 v[100:101], v13 offset:22528
  ds_read_b64_tr_b16 v[102:103], v13 offset:23040
  s_waitcnt lgkmcnt(6)
  v_mfma_f32_32x32x16_bf16 v[48:63], v[68:71], v[64:67], v[48:63]
  s_cmp_eq_u32 s76, 0
  s_cbranch_scc0 Lpub14
  s_getreg_b32 s77, hwreg(HW_REG_IB_STS)
  s_and_b32 s77, s77, 0xc0000f
  s_cbranch_scc1 Lpub14
  s_waitcnt vmcnt(0)
  s_setprio 3
  s_mov_b64 exec, 1
  buffer_store_dword v17, v16, s[16:19], 0 offen sc1
  s_mov_b64 exec, -1
  s_setprio 0
  s_mov_b32 s76, 1
Lpub14:
  s_waitcnt lgkmcnt(0)
  s_cmp_eq_u32 s76, 0
  s_cbranch_scc0 Lpub15
  s_getreg_b32 s77, hwreg(HW_REG_IB_STS)
  s_and_b32 s77, s77, 0xc0000f
  s_cbranch_scc1 Lpub15
  s_waitcnt vmcnt(0)
  s_setprio 3
  s_mov_b64 exec, 1
  buffer_store_dword v17, v16, s[16:19], 0 offen sc1
  s_mov_b64 exec, -1
  s_setprio 0
  s_mov_b32 s76, 1
Lpub15:
  s_barrier
  ds_read_b128 v[64:67], v8 offset:49152
  ds_read_b64_tr_b16 v[68:69], v12 offset:0
  ds_read_b64_tr_b16 v[70:71], v12 offset:512
  v_mfma_f32_32x32x16_bf16 v[48:63], v[84:87], v[80:83], v[48:63]
  ds_read_b128 v[80:83], v9 offset:49152
  ds_read_b64_tr_b16 v[84:85], v12 offset:2048
  ds_read_b64_tr_b16 v[86:87], v12 offset:2560
  v_mfma_f32_32x32x16_bf16 v[48:63], v[100:103], v[96:99], v[48:63]
  s_cmp_eq_u32 s76, 0
  s_cbranch_scc0 Lpub16
  s_getreg_b32 s77, hwreg(HW_REG_IB_STS)
  s_and_b32 s77, s77, 0xc0000f
  s_cbranch_scc1 Lpub16
  s_waitcnt vmcnt(0)
  s_setprio 3
  s_mov_b64 exec, 1
  buffer_store_dword v17, v16, s[16:19], 0 offen sc1
  s_mov_b64 exec, -1
  s_setprio 0
  s_mov_b32 s76, 1
Lpub16:
  ds_read_b128 v[96:99], v10 offset:49152
  ds_read_b64_tr_b16 v[100:101], v12 offset:4096
  ds_read_b64_tr_b16 v[102:103], v12 offset:4608
  s_waitcnt lgkmcnt(6)
  v_mfma_f32_32x32x16_bf16 v[48:63], v[68:71], v[64:67], v[48:63]
  ds_read_b128 v[64:67], v11 offset:49152
  ds_read_b64_tr_b16 v[68:69], v12 offset:6144
  ds_read_b64_tr_b16 v[70:71], v12 offset:6656
  s_waitcnt lgkmcnt(6)
  v_mfma_f32_32x32x16_bf16 v[48:63], v[84:87], v[80:83], v[48:63]
  s_cmp_eq_u32 s76, 0
  s_cbranch_scc0 Lpub17
  s_getreg_b32 s77, hwreg(HW_REG_IB_STS)
  s_and_b32 s77, s77, 0xc0000f
  s_cbranch_scc1 Lpub17
  s_waitcnt vmcnt(0)
  s_setprio 3
  s_mov_b64 exec, 1
  buffer_store_dword v17, v16, s[16:19], 0 offen sc1
  s_mov_b64 exec, -1
  s_setprio 0
  s_mov_b32 s76, 1
Lpub17:
  ds_read_b128 v[80:83], v8 offset:57344
  ds_read_b64_tr_b16 v[84:85], v12 offset:57344
  ds_read_b64_tr_b16 v[86:87], v12 offset:57856
  s_waitcnt lgkmcnt(6)
  v_mfma_f32_32x32x16_bf16 v[48:63], v[100:103], v[96:99], v[48:63]
  ds_read_b128 v[96:99], v9 offset:57344
  ds_read_b64_tr_b16 v[100:101], v12 offset:59392
  ds_read_b64_tr_b16 v[102:103], v12 offset:59904
  s_waitcnt lgkmcnt(6)
  v_mfma_f32_32x32x16_bf16 v[48:63], v[68:71], v[64:67], v[48:63]
  s_cmp_eq_u32 s76, 0
  s_cbranch_scc0 Lpub18
  s_getreg_b32 s77, hwreg(HW_REG_IB_STS)
  s_and_b32 s77, s77, 0xc0000f
  s_cbranch_scc1 Lpub18
  s_waitcnt vmcnt(0)
  s_setprio 3
  s_mov_b64 exec, 1
  buffer_store_dword v17, v16, s[16:19], 0 offen sc1
  s_mov_b64 exec, -1
  s_setprio 0
  s_mov_b32 s76, 1
Lpub18:
  ds_read_b128 v[64:67], v10 offset:57344
  ds_read_b64_tr_b16 v[68:69], v12 offset:61440
  ds_read_b64_tr_b16 v[70:71], v12 offset:61952
  s_waitcnt lgkmcnt(6)
  v_mfma_f32_32x32x16_bf16 v[48:63], v[84:87], v[80:83], v[48:63]
  ds_read_b128 v[80:83], v11 offset:57344
  ds_read_b64_tr_b16 v[84:85], v12 offset:63488
  ds_read_b64_tr_b16 v[86:87], v12 offset:64000
  s_waitcnt lgkmcnt(6)
  v_mfma_f32_32x32x16_bf16 v[48:63], v[100:103], v[96:99], v[48:63]
  s_cmp_eq_u32 s76, 0
  s_cbranch_scc0 Lpub19
  s_getreg_b32 s77, hwreg(HW_REG_IB_STS)
  s_and_b32 s77, s77, 0xc0000f
  s_cbranch_scc1 Lpub19
  s_waitcnt vmcnt(0)
  s_setprio 3
  s_mov_b64 exec, 1
  buffer_store_dword v17, v16, s[16:19], 0 offen sc1
  s_mov_b64 exec, -1
  s_setprio 0
  s_mov_b32 s76, 1
Lpub19:
  s_waitcnt lgkmcnt(0)
  s_cmp_eq_u32 s76, 0
  s_cbranch_scc0 Lpub20
  s_waitcnt vmcnt(0)
  s_setprio 3
  s_mov_b64 exec, 1
  buffer_store_dword v17, v16, s[16:19], 0 offen sc1
  s_mov_b64 exec, -1
  s_setprio 0
  s_mov_b32 s76, 1
Lpub20:
  s_barrier
  s_setprio 3
  v_mfma_f32_32x32x16_bf16 v[48:63], v[68:71], v[64:67], v[48:63]
  v_mfma_f32_32x32x16_bf16 v[48:63], v[84:87], v[80:83], v[48:63]
  s_and_b32 s51, s3, 3
  s_lshr_b32 s52, s3, 2
  s_lshl_b32 s53, s5, 2
  s_add_u32 s61, s53, s51
  s_lshl_b32 s53, s61, 17
  s_add_u32 s57, s53, 1048576
  s_lshl_b32 s54, s52, 11
  s_add_u32 s53, s57, s54
  s_lshl_b32 s54, s4, 1
  s_add_u32 s54, s54, s52
  s_lshl_b32 s54, s54, 5
  s_add_u32 s61, s61, s54
  s_lshl_b32 s61, s61, 10
  s_add_u32 s61, s61, 9437184
  s_lshl_b32 s54, s4, 12
  s_mov_b32 s58, 0x0000ffff
  s_mov_b32 s59, 0x0000ffff
  v_pk_mul_f32 v[48:49], v[48:49], s[74:75] op_sel:[0,1] op_sel_hi:[1,1]
  v_pk_mul_f32 v[50:51], v[50:51], s[74:75] op_sel:[0,1] op_sel_hi:[1,1]
  v_pk_mul_f32 v[52:53], v[52:53], s[74:75] op_sel:[0,1] op_sel_hi:[1,1]
  v_pk_mul_f32 v[54:55], v[54:55], s[74:75] op_sel:[0,1] op_sel_hi:[1,1]
  v_pk_mul_f32 v[56:57], v[56:57], s[74:75] op_sel:[0,1] op_sel_hi:[1,1]
  v_pk_mul_f32 v[58:59], v[58:59], s[74:75] op_sel:[0,1] op_sel_hi:[1,1]
  v_pk_mul_f32 v[60:61], v[60:61], s[74:75] op_sel:[0,1] op_sel_hi:[1,1]
  v_pk_mul_f32 v[62:63], v[62:63], s[74:75] op_sel:[0,1] op_sel_hi:[1,1]
  v_cvt_pk_bf16_f32 v32, v48, v49
  v_cvt_pk_bf16_f32 v33, v50, v51
  v_cvt_pk_bf16_f32 v34, v52, v53
  v_cvt_pk_bf16_f32 v35, v54, v55
  ds_write_b128 v7, v[32:35] offset:0
  ds_write_b128 v7, v[32:35] offset:12288
  v_cvt_pk_bf16_f32 v36, v56, v57
  v_cvt_pk_bf16_f32 v37, v58, v59
  v_cvt_pk_bf16_f32 v38, v60, v61
  v_cvt_pk_bf16_f32 v39, v62, v63
  ds_write_b128 v7, v[36:39] offset:3072
  ds_write_b128 v7, v[36:39] offset:15360
  s_setprio 0
  s_add_u32 s56, s53, s54
  buffer_load_dwordx4 v[80:83], v160, s[16:19], s56 offen sc1
  s_add_u32 s54, s54, 4096
  s_and_b32 s54, s54, 0x1ffff
  s_mov_b64 exec, s[58:59]
  buffer_load_dwordx4 v[144:147], v161, s[16:19], s56 offen offset:1024 sc1
  buffer_load_dwordx4 v[148:151], v161, s[16:19], s56 offen offset:1536 sc1
  s_mov_b64 exec, -1
  s_waitcnt lgkmcnt(0)
  s_barrier
L_att_pre:
  s_setprio 2
  v_add_u32 v2, s70, v160
  ds_read_b128 v[8:11], v2
  ds_read_b128 v[12:15], v2 offset:1024
  s_add_u32 s56, s53, s54
  buffer_load_dwordx4 v[84:87], v160, s[16:19], s56 offen sc1
  s_add_u32 s54, s54, 4096
  s_and_b32 s54, s54, 0x1ffff
  s_mov_b64 exec, s[58:59]
  buffer_load_dwordx4 v[152:155], v161, s[16:19], s56 offen offset:1024 sc1
  buffer_load_dwordx4 v[156:159], v161, s[16:19], s56 offen offset:1536 sc1
  s_mov_b64 exec, -1
  s_add_u32 s56, s53, s54
  buffer_load_dwordx4 v[88:91], v160, s[16:19], s56 offen sc1
  s_add_u32 s54, s54, 4096
  s_and_b32 s54, s54, 0x1ffff
  s_add_u32 m0, s70, 1024
  s_nop 0
  buffer_load_dwordx4 v160, s[16:19], s56 offen offset:1024 sc1 lds
  v_and_b32 v162, 31, v0
  v_and_b32 v3, 3, v162
  v_lshrrev_b32 v163, 3, v162
  v_lshl_add_u32 v3, v163, 2, v3
  v_and_b32 v163, 4, v162
  v_lshl_add_u32 v3, v163, 2, v3
  s_lshl_b32 s55, s52, 7
  s_add_u32 s55, s55, 162816
  v_lshlrev_b32 v3, 2, v3
  v_add_u32 v3, s55, v3
  ds_read_b32 v1, v3
  s_cmp_eq_u32 s52, 0
  s_cbranch_scc0 L_noprio
  s_setprio 1
L_noprio:
  s_waitcnt vmcnt(5) lgkmcnt(0)
  v_mfma_f32_32x32x16_bf16 v[16:31], v[80:83], v[8:11], 0
  v_sub_f32 v1, 1.0, v1
  s_nop 0
  v_cvt_pk_bf16_f32 v1, v1, v1
  v_and_b32 v1, 0xffff0000, v1
  s_nop 8
  v_exp_f32 v16, v16
  v_exp_f32 v17, v17
  v_exp_f32 v18, v18
  v_exp_f32 v19, v19
  v_exp_f32 v20, v20
  v_exp_f32 v21, v21
  v_mfma_f32_32x32x16_bf16 v[32:47], v[80:83], v[12:15], 0
  v_exp_f32 v22, v22
  v_exp_f32 v23, v23
  s_add_u32 s56, s53, s54
  buffer_load_dwordx4 v[80:83], v160, s[16:19], s56 offen sc1
  s_add_u32 s54, s54, 4096
  s_and_b32 s54, s54, 0x1ffff
  v_exp_f32 v24, v24
  v_exp_f32 v25, v25
  v_exp_f32 v26, v26
  v_exp_f32 v27, v27
  v_smfmac_f32_32x32x32_bf16 v[112:127], v[144:147], v[16:23], v164
  v_exp_f32 v28, v28
  v_exp_f32 v29, v29
  s_add_u32 m0, s70, -1024
  s_nop 0
  buffer_load_dwordx4 v160, s[16:19], s56 offen offset:1024 sc1 lds
  v_exp_f32 v30, v30
  v_exp_f32 v31, v31
  v_exp_f32 v32, v32
  v_exp_f32 v33, v33
  v_smfmac_f32_32x32x32_bf16 v[112:127], v[148:151], v[24:31], v164
  v_exp_f32 v34, v34
  v_exp_f32 v35, v35
  v_exp_f32 v36, v36
  v_exp_f32 v37, v37
  s_waitcnt vmcnt(4)
  v_mfma_f32_32x32x16_bf16 v[16:31], v[84:87], v[8:11], 0
  v_exp_f32 v38, v38
  v_exp_f32 v39, v39
  v_exp_f32 v40, v40
  v_exp_f32 v41, v41
  v_exp_f32 v42, v42
  v_exp_f32 v43, v43
  v_smfmac_f32_32x32x32_bf16 v[128:143], v[144:147], v[32:39], v164
  v_exp_f32 v44, v44
  v_exp_f32 v45, v45
  v_exp_f32 v46, v46
  v_exp_f32 v47, v47
  v_exp_f32 v16, v16
  v_exp_f32 v17, v17
  v_smfmac_f32_32x32x32_bf16 v[128:143], v[148:151], v[40:47], v164
  v_exp_f32 v18, v18
  v_exp_f32 v19, v19
  v_exp_f32 v20, v20
  v_exp_f32 v21, v21
  v_mfma_f32_32x32x16_bf16 v[32:47], v[84:87], v[12:15], 0
  v_exp_f32 v22, v22
  v_exp_f32 v23, v23
  s_add_u32 s56, s53, s54
  buffer_load_dwordx4 v[84:87], v160, s[16:19], s56 offen sc1
  s_add_u32 s54, s54, 4096
  s_and_b32 s54, s54, 0x1ffff
  v_exp_f32 v24, v24
  v_exp_f32 v25, v25
  v_exp_f32 v26, v26
  v_exp_f32 v27, v27
  v_smfmac_f32_32x32x32_bf16 v[112:127], v[152:155], v[16:23], v164
  v_exp_f32 v28, v28
  v_exp_f32 v29, v29
  s_add_u32 m0, s70, 0
  s_nop 0
  buffer_load_dwordx4 v160, s[16:19], s56 offen offset:1024 sc1 lds
  v_exp_f32 v30, v30
  v_exp_f32 v31, v31
  v_exp_f32 v32, v32
  v_exp_f32 v33, v33
  v_smfmac_f32_32x32x32_bf16 v[112:127], v[156:159], v[24:31], v164
  v_exp_f32 v34, v34
  v_exp_f32 v35, v35
  v_exp_f32 v36, v36
  v_exp_f32 v37, v37
  s_waitcnt vmcnt(4)
  v_mfma_f32_32x32x16_bf16 v[16:31], v[88:91], v[8:11], 0
  v_exp_f32 v38, v38
  v_exp_f32 v39, v39
  s_mov_b64 exec, s[58:59]
  ds_read_b128 v[144:147], v165 offset:2048
  ds_read_b128 v[148:151], v165 offset:2560
  s_mov_b64 exec, -1
  v_exp_f32 v40, v40
  v_exp_f32 v41, v41
  v_exp_f32 v42, v42
  v_exp_f32 v43, v43
  v_smfmac_f32_32x32x32_bf16 v[128:143], v[152:155], v[32:39], v164
  v_exp_f32 v44, v44
  v_exp_f32 v45, v45
  v_exp_f32 v46, v46
  v_exp_f32 v47, v47
  v_exp_f32 v16, v16
  v_exp_f32 v17, v17
  v_smfmac_f32_32x32x32_bf16 v[128:143], v[156:159], v[40:47], v164
  v_exp_f32 v18, v18
  v_exp_f32 v19, v19
  v_exp_f32 v20, v20
  v_exp_f32 v21, v21
  s_waitcnt lgkmcnt(0)
  v_mfma_f32_32x32x16_bf16 v[32:47], v[88:91], v[12:15], 0
  v_exp_f32 v22, v22
  v_exp_f32 v23, v23
  s_add_u32 s56, s53, s54
  buffer_load_dwordx4 v[88:91], v160, s[16:19], s56 offen sc1
  s_add_u32 s54, s54, 4096
  s_and_b32 s54, s54, 0x1ffff
  v_exp_f32 v24, v24
  v_exp_f32 v25, v25
  v_exp_f32 v26, v26
  v_exp_f32 v27, v27
  v_smfmac_f32_32x32x32_bf16 v[112:127], v[144:147], v[16:23], v164
  v_exp_f32 v28, v28
  v_exp_f32 v29, v29
  s_add_u32 m0, s70, 1024
  s_nop 0
  buffer_load_dwordx4 v160, s[16:19], s56 offen offset:1024 sc1 lds
  v_exp_f32 v30, v30
  v_exp_f32 v31, v31
  v_exp_f32 v32, v32
  v_exp_f32 v33, v33
  v_smfmac_f32_32x32x32_bf16 v[112:127], v[148:151], v[24:31], v164
  v_exp_f32 v34, v34
  v_exp_f32 v35, v35
  v_exp_f32 v36, v36
  v_exp_f32 v37, v37
  s_waitcnt vmcnt(4)
  v_mfma_f32_32x32x16_bf16 v[16:31], v[80:83], v[8:11], 0
  v_exp_f32 v38, v38
  v_exp_f32 v39, v39
  s_mov_b64 exec, s[58:59]
  ds_read_b128 v[152:155], v165 offset:0
  ds_read_b128 v[156:159], v165 offset:512
  s_mov_b64 exec, -1
  v_exp_f32 v40, v40
  v_exp_f32 v41, v41
  v_exp_f32 v42, v42
  v_exp_f32 v43, v43
  v_smfmac_f32_32x32x32_bf16 v[128:143], v[144:147], v[32:39], v164
  v_exp_f32 v44, v44
  v_exp_f32 v45, v45
  v_exp_f32 v46, v46
  v_exp_f32 v47, v47
  v_exp_f32 v16, v16
  v_exp_f32 v17, v17
  v_smfmac_f32_32x32x32_bf16 v[128:143], v[148:151], v[40:47], v164
  v_exp_f32 v18, v18
  v_exp_f32 v19, v19
  v_exp_f32 v20, v20
  v_exp_f32 v21, v21
  s_waitcnt lgkmcnt(0)
  v_mfma_f32_32x32x16_bf16 v[32:47], v[80:83], v[12:15], 0
  v_exp_f32 v22, v22
  v_exp_f32 v23, v23
  s_add_u32 s56, s53, s54
  buffer_load_dwordx4 v[80:83], v160, s[16:19], s56 offen sc1
  s_add_u32 s54, s54, 4096
  s_and_b32 s54, s54, 0x1ffff
  v_exp_f32 v24, v24
  v_exp_f32 v25, v25
  v_exp_f32 v26, v26
  v_exp_f32 v27, v27
  v_smfmac_f32_32x32x32_bf16 v[112:127], v[152:155], v[16:23], v164
  v_exp_f32 v28, v28
  v_exp_f32 v29, v29
  s_add_u32 m0, s70, -1024
  s_nop 0
  buffer_load_dwordx4 v160, s[16:19], s56 offen offset:1024 sc1 lds
  v_exp_f32 v30, v30
  v_exp_f32 v31, v31
  v_exp_f32 v32, v32
  v_exp_f32 v33, v33
  v_smfmac_f32_32x32x32_bf16 v[112:127], v[156:159], v[24:31], v164
  v_exp_f32 v34, v34
  v_exp_f32 v35, v35
  v_exp_f32 v36, v36
  v_exp_f32 v37, v37
  s_waitcnt vmcnt(4)
  v_mfma_f32_32x32x16_bf16 v[16:31], v[84:87], v[8:11], 0
  v_exp_f32 v38, v38
  v_exp_f32 v39, v39
  s_mov_b64 exec, s[58:59]
  ds_read_b128 v[144:147], v165 offset:1024
  ds_read_b128 v[148:151], v165 offset:1536
  s_mov_b64 exec, -1
  v_exp_f32 v40, v40
  v_exp_f32 v41, v41
  v_exp_f32 v42, v42
  v_exp_f32 v43, v43
  v_smfmac_f32_32x32x32_bf16 v[128:143], v[152:155], v[32:39], v164
  v_exp_f32 v44, v44
  v_exp_f32 v45, v45
  v_exp_f32 v46, v46
  v_exp_f32 v47, v47
  v_exp_f32 v16, v16
  v_exp_f32 v17, v17
  v_smfmac_f32_32x32x32_bf16 v[128:143], v[156:159], v[40:47], v164
  v_exp_f32 v18, v18
  v_exp_f32 v19, v19
  v_exp_f32 v20, v20
  v_exp_f32 v21, v21
  s_waitcnt lgkmcnt(0)
  v_mfma_f32_32x32x16_bf16 v[32:47], v[84:87], v[12:15], 0
  v_exp_f32 v22, v22
  v_exp_f32 v23, v23
  s_add_u32 s56, s53, s54
  buffer_load_dwordx4 v[84:87], v160, s[16:19], s56 offen sc1
  s_add_u32 s54, s54, 4096
  s_and_b32 s54, s54, 0x1ffff
  v_exp_f32 v24, v24
  v_exp_f32 v25, v25
  v_exp_f32 v26, v26
  v_exp_f32 v27, v27
  v_smfmac_f32_32x32x32_bf16 v[112:127], v[144:147], v[16:23], v164
  v_exp_f32 v28, v28
  v_exp_f32 v29, v29
  s_add_u32 m0, s70, 0
  s_nop 0
  buffer_load_dwordx4 v160, s[16:19], s56 offen offset:1024 sc1 lds
  v_exp_f32 v30, v30
  v_exp_f32 v31, v31
  v_exp_f32 v32, v32
  v_exp_f32 v33, v33
  v_smfmac_f32_32x32x32_bf16 v[112:127], v[148:151], v[24:31], v164
  v_exp_f32 v34, v34
  v_exp_f32 v35, v35
  v_exp_f32 v36, v36
  v_exp_f32 v37, v37
  s_waitcnt vmcnt(4)
  v_mfma_f32_32x32x16_bf16 v[16:31], v[88:91], v[8:11], 0
  v_exp_f32 v38, v38
  v_exp_f32 v39, v39
  s_mov_b64 exec, s[58:59]
  ds_read_b128 v[152:155], v165 offset:2048
  ds_read_b128 v[156:159], v165 offset:2560
  s_mov_b64 exec, -1
  v_exp_f32 v40, v40
  v_exp_f32 v41, v41
  v_exp_f32 v42, v42
  v_exp_f32 v43, v43
  v_smfmac_f32_32x32x32_bf16 v[128:143], v[144:147], v[32:39], v164
  v_exp_f32 v44, v44
  v_exp_f32 v45, v45
  v_exp_f32 v46, v46
  v_exp_f32 v47, v47
  v_mov_b32 v162, 163092
  s_mov_b32 s49, 0
Llw21:
  ds_read_b32 v163, v162
  s_add_u32 s49, s49, 1
  s_waitcnt lgkmcnt(0)
  v_readfirstlane_b32 s50, v163
  s_cmp_gt_u32 s49, 1600000
  s_cbranch_scc1 Llwgo22
  s_cmp_ge_u32 s50, 1
  s_cbranch_scc1 Llwgo22
  s_sleep 1
  s_branch Llw21
Llwgo22:
  s_mov_b32 s60, 4
  .p2align 6
L_att_loop:
  v_exp_f32 v16, v16
  v_exp_f32 v17, v17
  v_smfmac_f32_32x32x32_bf16 v[128:143], v[148:151], v[40:47], v164
  v_exp_f32 v18, v18
  v_exp_f32 v19, v19
  v_exp_f32 v20, v20
  v_exp_f32 v21, v21
  s_waitcnt lgkmcnt(0)
  v_mfma_f32_32x32x16_bf16 v[32:47], v[88:91], v[12:15], 0
  v_exp_f32 v22, v22
  v_exp_f32 v23, v23
  s_add_u32 s56, s53, s54
  buffer_load_dwordx4 v[88:91], v160, s[16:19], s56 offen sc1
  s_add_u32 s54, s54, 4096
  s_and_b32 s54, s54, 0x1ffff
  v_exp_f32 v24, v24
  v_exp_f32 v25, v25
  v_exp_f32 v26, v26
  v_exp_f32 v27, v27
  v_smfmac_f32_32x32x32_bf16 v[112:127], v[152:155], v[16:23], v164
  v_exp_f32 v28, v28
  v_exp_f32 v29, v29
  s_add_u32 m0, s70, 1024
  s_nop 0
  buffer_load_dwordx4 v160, s[16:19], s56 offen offset:1024 sc1 lds
  v_exp_f32 v30, v30
  v_exp_f32 v31, v31
  v_exp_f32 v32, v32
  v_exp_f32 v33, v33
  v_smfmac_f32_32x32x32_bf16 v[112:127], v[156:159], v[24:31], v164
  v_exp_f32 v34, v34
  v_exp_f32 v35, v35
  v_exp_f32 v36, v36
  v_exp_f32 v37, v37
  s_waitcnt vmcnt(4)
  v_mfma_f32_32x32x16_bf16 v[16:31], v[80:83], v[8:11], 0
  v_exp_f32 v38, v38
  v_exp_f32 v39, v39
  s_mov_b64 exec, s[58:59]
  ds_read_b128 v[144:147], v165 offset:0
  ds_read_b128 v[148:151], v165 offset:512
  s_mov_b64 exec, -1
  v_exp_f32 v40, v40
  v_exp_f32 v41, v41
  v_exp_f32 v42, v42
  v_exp_f32 v43, v43
  v_smfmac_f32_32x32x32_bf16 v[128:143], v[152:155], v[32:39], v164
  v_exp_f32 v44, v44
  v_exp_f32 v45, v45
  v_exp_f32 v46, v46
  v_exp_f32 v47, v47
  v_exp_f32 v16, v16
  v_exp_f32 v17, v17
  v_smfmac_f32_32x32x32_bf16 v[128:143], v[156:159], v[40:47], v164
  v_exp_f32 v18, v18
  v_exp_f32 v19, v19
  v_exp_f32 v20, v20
  v_exp_f32 v21, v21
  s_waitcnt lgkmcnt(0)
  v_mfma_f32_32x32x16_bf16 v[32:47], v[80:83], v[12:15], 0
  v_exp_f32 v22, v22
  v_exp_f32 v23, v23
  s_add_u32 s56, s53, s54
  buffer_load_dwordx4 v[80:83], v160, s[16:19], s56 offen sc1
  s_add_u32 s54, s54, 4096
  s_and_b32 s54, s54, 0x1ffff
  v_exp_f32 v24, v24
  v_exp_f32 v25, v25
  v_exp_f32 v26, v26
  v_exp_f32 v27, v27
  v_smfmac_f32_32x32x32_bf16 v[112:127], v[144:147], v[16:23], v164
  v_exp_f32 v28, v28
  v_exp_f32 v29, v29
  s_add_u32 m0, s70, -1024
  s_nop 0
  buffer_load_dwordx4 v160, s[16:19], s56 offen offset:1024 sc1 lds
  v_exp_f32 v30, v30
  v_exp_f32 v31, v31
  v_exp_f32 v32, v32
  v_exp_f32 v33, v33
  v_smfmac_f32_32x32x32_bf16 v[112:127], v[148:151], v[24:31], v164
  v_exp_f32 v34, v34
  v_exp_f32 v35, v35
  v_exp_f32 v36, v36
  v_exp_f32 v37, v37
  s_waitcnt vmcnt(4)
  v_mfma_f32_32x32x16_bf16 v[16:31], v[84:87], v[8:11], 0
  v_exp_f32 v38, v38
  v_exp_f32 v39, v39
  s_mov_b64 exec, s[58:59]
  ds_read_b128 v[152:155], v165 offset:1024
  ds_read_b128 v[156:159], v165 offset:1536
  s_mov_b64 exec, -1
  v_exp_f32 v40, v40
  v_exp_f32 v41, v41
  v_exp_f32 v42, v42
  v_exp_f32 v43, v43
  v_smfmac_f32_32x32x32_bf16 v[128:143], v[144:147], v[32:39], v164
  v_exp_f32 v44, v44
  v_exp_f32 v45, v45
  v_exp_f32 v46, v46
  v_exp_f32 v47, v47
  v_exp_f32 v16, v16
  v_exp_f32 v17, v17
  v_smfmac_f32_32x32x32_bf16 v[128:143], v[148:151], v[40:47], v164
  v_exp_f32 v18, v18
  v_exp_f32 v19, v19
  v_exp_f32 v20, v20
  v_exp_f32 v21, v21
  s_waitcnt lgkmcnt(0)
  v_mfma_f32_32x32x16_bf16 v[32:47], v[84:87], v[12:15], 0
  v_exp_f32 v22, v22
  v_exp_f32 v23, v23
  s_add_u32 s56, s53, s54
  buffer_load_dwordx4 v[84:87], v160, s[16:19], s56 offen sc1
  s_add_u32 s54, s54, 4096
  s_and_b32 s54, s54, 0x1ffff
  v_exp_f32 v24, v24
  v_exp_f32 v25, v25
  v_exp_f32 v26, v26
  v_exp_f32 v27, v27
  v_smfmac_f32_32x32x32_bf16 v[112:127], v[152:155], v[16:23], v164
  v_exp_f32 v28, v28
  v_exp_f32 v29, v29
  s_add_u32 m0, s70, 0
  s_nop 0
  buffer_load_dwordx4 v160, s[16:19], s56 offen offset:1024 sc1 lds
  v_exp_f32 v30, v30
  v_exp_f32 v31, v31
  v_exp_f32 v32, v32
  v_exp_f32 v33, v33
  v_smfmac_f32_32x32x32_bf16 v[112:127], v[156:159], v[24:31], v164
  v_exp_f32 v34, v34
  v_exp_f32 v35, v35
  v_exp_f32 v36, v36
  v_exp_f32 v37, v37
  s_waitcnt vmcnt(4)
  v_mfma_f32_32x32x16_bf16 v[16:31], v[88:91], v[8:11], 0
  v_exp_f32 v38, v38
  v_exp_f32 v39, v39
  s_mov_b64 exec, s[58:59]
  ds_read_b128 v[144:147], v165 offset:2048
  ds_read_b128 v[148:151], v165 offset:2560
  s_mov_b64 exec, -1
  v_exp_f32 v40, v40
  v_exp_f32 v41, v41
  v_exp_f32 v42, v42
  v_exp_f32 v43, v43
  v_smfmac_f32_32x32x32_bf16 v[128:143], v[152:155], v[32:39], v164
  v_exp_f32 v44, v44
  v_exp_f32 v45, v45
  v_exp_f32 v46, v46
  v_exp_f32 v47, v47
  v_exp_f32 v16, v16
  v_exp_f32 v17, v17
  v_smfmac_f32_32x32x32_bf16 v[128:143], v[156:159], v[40:47], v164
  v_exp_f32 v18, v18
  v_exp_f32 v19, v19
  v_exp_f32 v20, v20
  v_exp_f32 v21, v21
  s_waitcnt lgkmcnt(0)
  v_mfma_f32_32x32x16_bf16 v[32:47], v[88:91], v[12:15], 0
  v_exp_f32 v22, v22
  v_exp_f32 v23, v23
  s_add_u32 s56, s53, s54
  buffer_load_dwordx4 v[88:91], v160, s[16:19], s56 offen sc1
  s_add_u32 s54, s54, 4096
  s_and_b32 s54, s54, 0x1ffff
  v_exp_f32 v24, v24
  v_exp_f32 v25, v25
  v_exp_f32 v26, v26
  v_exp_f32 v27, v27
  v_smfmac_f32_32x32x32_bf16 v[112:127], v[144:147], v[16:23], v164
  v_exp_f32 v28, v28
  v_exp_f32 v29, v29
  s_add_u32 m0, s70, 1024
  s_nop 0
  buffer_load_dwordx4 v160, s[16:19], s56 offen offset:1024 sc1 lds
  v_exp_f32 v30, v30
  v_exp_f32 v31, v31
  v_exp_f32 v32, v32
  v_exp_f32 v33, v33
  v_smfmac_f32_32x32x32_bf16 v[112:127], v[148:151], v[24:31], v164
  v_exp_f32 v34, v34
  v_exp_f32 v35, v35
  v_exp_f32 v36, v36
  v_exp_f32 v37, v37
  s_waitcnt vmcnt(4)
  v_mfma_f32_32x32x16_bf16 v[16:31], v[80:83], v[8:11], 0
  v_exp_f32 v38, v38
  v_exp_f32 v39, v39
  s_mov_b64 exec, s[58:59]
  ds_read_b128 v[152:155], v165 offset:0
  ds_read_b128 v[156:159], v165 offset:512
  s_mov_b64 exec, -1
  v_exp_f32 v40, v40
  v_exp_f32 v41, v41
  v_exp_f32 v42, v42
  v_exp_f32 v43, v43
  v_smfmac_f32_32x32x32_bf16 v[128:143], v[144:147], v[32:39], v164
  v_exp_f32 v44, v44
  v_exp_f32 v45, v45
  v_exp_f32 v46, v46
  v_exp_f32 v47, v47
  v_exp_f32 v16, v16
  v_exp_f32 v17, v17
  v_smfmac_f32_32x32x32_bf16 v[128:143], v[148:151], v[40:47], v164
  v_exp_f32 v18, v18
  v_exp_f32 v19, v19
  v_exp_f32 v20, v20
  v_exp_f32 v21, v21
  s_waitcnt lgkmcnt(0)
  v_mfma_f32_32x32x16_bf16 v[32:47], v[80:83], v[12:15], 0
  v_exp_f32 v22, v22
  v_exp_f32 v23, v23
  s_add_u32 s56, s53, s54
  buffer_load_dwordx4 v[80:83], v160, s[16:19], s56 offen sc1
  s_add_u32 s54, s54, 4096
  s_and_b32 s54, s54, 0x1ffff
  v_exp_f32 v24, v24
  v_exp_f32 v25, v25
  v_exp_f32 v26, v26
  v_exp_f32 v27, v27
  v_smfmac_f32_32x32x32_bf16 v[112:127], v[152:155], v[16:23], v164
  v_exp_f32 v28, v28
  v_exp_f32 v29, v29
  s_add_u32 m0, s70, -1024
  s_nop 0
  buffer_load_dwordx4 v160, s[16:19], s56 offen offset:1024 sc1 lds
  v_exp_f32 v30, v30
  v_exp_f32 v31, v31
  v_exp_f32 v32, v32
  v_exp_f32 v33, v33
  v_smfmac_f32_32x32x32_bf16 v[112:127], v[156:159], v[24:31], v164
  v_exp_f32 v34, v34
  v_exp_f32 v35, v35
  v_exp_f32 v36, v36
  v_exp_f32 v37, v37
  s_waitcnt vmcnt(4)
  v_mfma_f32_32x32x16_bf16 v[16:31], v[84:87], v[8:11], 0
  v_exp_f32 v38, v38
  v_exp_f32 v39, v39
  s_mov_b64 exec, s[58:59]
  ds_read_b128 v[144:147], v165 offset:1024
  ds_read_b128 v[148:151], v165 offset:1536
  s_mov_b64 exec, -1
  v_exp_f32 v40, v40
  v_exp_f32 v41, v41
  v_exp_f32 v42, v42
  v_exp_f32 v43, v43
  v_smfmac_f32_32x32x32_bf16 v[128:143], v[152:155], v[32:39], v164
  v_exp_f32 v44, v44
  v_exp_f32 v45, v45
  v_exp_f32 v46, v46
  v_exp_f32 v47, v47
  v_exp_f32 v16, v16
  v_exp_f32 v17, v17
  v_smfmac_f32_32x32x32_bf16 v[128:143], v[156:159], v[40:47], v164
  v_exp_f32 v18, v18
  v_exp_f32 v19, v19
  v_exp_f32 v20, v20
  v_exp_f32 v21, v21
  s_waitcnt lgkmcnt(0)
  v_mfma_f32_32x32x16_bf16 v[32:47], v[84:87], v[12:15], 0
  v_exp_f32 v22, v22
  v_exp_f32 v23, v23
  s_add_u32 s56, s53, s54
  buffer_load_dwordx4 v[84:87], v160, s[16:19], s56 offen sc1
  s_add_u32 s54, s54, 4096
  s_and_b32 s54, s54, 0x1ffff
  v_exp_f32 v24, v24
  v_exp_f32 v25, v25
  v_exp_f32 v26, v26
  v_exp_f32 v27, v27
  v_smfmac_f32_32x32x32_bf16 v[112:127], v[144:147], v[16:23], v164
  v_exp_f32 v28, v28
  v_exp_f32 v29, v29
  s_add_u32 m0, s70, 0
  s_nop 0
  buffer_load_dwordx4 v160, s[16:19], s56 offen offset:1024 sc1 lds
  v_exp_f32 v30, v30
  v_exp_f32 v31, v31
  v_exp_f32 v32, v32
  v_exp_f32 v33, v33
  v_smfmac_f32_32x32x32_bf16 v[112:127], v[148:151], v[24:31], v164
  v_exp_f32 v34, v34
  v_exp_f32 v35, v35
  v_exp_f32 v36, v36
  v_exp_f32 v37, v37
  s_waitcnt vmcnt(4)
  v_mfma_f32_32x32x16_bf16 v[16:31], v[88:91], v[8:11], 0
  v_exp_f32 v38, v38
  v_exp_f32 v39, v39
  s_mov_b64 exec, s[58:59]
  ds_read_b128 v[152:155], v165 offset:2048
  ds_read_b128 v[156:159], v165 offset:2560
  s_mov_b64 exec, -1
  v_exp_f32 v40, v40
  v_exp_f32 v41, v41
  v_exp_f32 v42, v42
  v_exp_f32 v43, v43
  v_smfmac_f32_32x32x32_bf16 v[128:143], v[144:147], v[32:39], v164
  s_sub_u32 s60, s60, 1
  s_cmp_eq_u32 s60, 1
  s_cbranch_scc0 L_keepprio
  s_setprio 1
L_keepprio:
  s_cmp_lg_u32 s60, 0
  v_exp_f32 v44, v44
  v_exp_f32 v45, v45
  v_exp_f32 v46, v46
  v_exp_f32 v47, v47
  s_cbranch_scc1 L_att_loop
  v_exp_f32 v16, v16
  v_exp_f32 v17, v17
  v_smfmac_f32_32x32x32_bf16 v[128:143], v[148:151], v[40:47], v164
  v_exp_f32 v18, v18
  v_exp_f32 v19, v19
  v_exp_f32 v20, v20
  v_exp_f32 v21, v21
  s_waitcnt lgkmcnt(0)
  v_mfma_f32_32x32x16_bf16 v[32:47], v[88:91], v[12:15], 0
  v_exp_f32 v22, v22
  v_exp_f32 v23, v23
  v_exp_f32 v24, v24
  v_exp_f32 v25, v25
  v_exp_f32 v26, v26
  v_exp_f32 v27, v27
  v_smfmac_f32_32x32x32_bf16 v[112:127], v[152:155], v[16:23], v164
  v_exp_f32 v28, v28
  v_exp_f32 v29, v29
  v_exp_f32 v30, v30
  v_exp_f32 v31, v31
  v_exp_f32 v32, v32
  v_exp_f32 v33, v33
  v_smfmac_f32_32x32x32_bf16 v[112:127], v[156:159], v[24:31], v164
  v_exp_f32 v34, v34
  v_exp_f32 v35, v35
  v_exp_f32 v36, v36
  v_exp_f32 v37, v37
  s_waitcnt vmcnt(2)
  v_mfma_f32_32x32x16_bf16 v[16:31], v[80:83], v[8:11], 0
  v_exp_f32 v38, v38
  v_exp_f32 v39, v39
  s_mov_b64 exec, s[58:59]
  ds_read_b128 v[144:147], v165 offset:0
  ds_read_b128 v[148:151], v165 offset:512
  s_mov_b64 exec, -1
  v_exp_f32 v40, v40
  v_exp_f32 v41, v41
  v_exp_f32 v42, v42
  v_exp_f32 v43, v43
  v_smfmac_f32_32x32x32_bf16 v[128:143], v[152:155], v[32:39], v164
  v_exp_f32 v44, v44
  v_exp_f32 v45, v45
  v_exp_f32 v46, v46
  v_exp_f32 v47, v47
  v_exp_f32 v16, v16
  v_exp_f32 v17, v17
  v_smfmac_f32_32x32x32_bf16 v[128:143], v[156:159], v[40:47], v164
  v_exp_f32 v18, v18
  v_exp_f32 v19, v19
  v_exp_f32 v20, v20
  v_exp_f32 v21, v21
  s_waitcnt lgkmcnt(0)
  v_mfma_f32_32x32x16_bf16 v[32:47], v[80:83], v[12:15], 0
  v_exp_f32 v22, v22
  v_exp_f32 v23, v23
  v_exp_f32 v24, v24
  v_exp_f32 v25, v25
  v_exp_f32 v26, v26
  v_exp_f32 v27, v27
  v_smfmac_f32_32x32x32_bf16 v[112:127], v[144:147], v[16:23], v164
  v_exp_f32 v28, v28
  v_exp_f32 v29, v29
  v_exp_f32 v30, v30
  v_exp_f32 v31, v31
  v_exp_f32 v32, v32
  v_exp_f32 v33, v33
  v_smfmac_f32_32x32x32_bf16 v[112:127], v[148:151], v[24:31], v164
  v_exp_f32 v34, v34
  v_exp_f32 v35, v35
  v_exp_f32 v36, v36
  v_exp_f32 v37, v37
  s_waitcnt vmcnt(0)
  v_mfma_f32_32x32x16_bf16 v[16:31], v[84:87], v[8:11], 0
  v_exp_f32 v38, v38
  v_exp_f32 v39, v39
  s_mov_b64 exec, s[58:59]
  ds_read_b128 v[152:155], v165 offset:1024
  ds_read_b128 v[156:159], v165 offset:1536
  s_mov_b64 exec, -1
  v_exp_f32 v40, v40
  v_exp_f32 v41, v41
  v_exp_f32 v42, v42
  v_exp_f32 v43, v43
  v_smfmac_f32_32x32x32_bf16 v[128:143], v[144:147], v[32:39], v164
  v_add_u32 v162, s70, v160
  s_xor_b32 s56, s3, 4
  s_mul_i32 s55, s56, 3072
  s_add_u32 s55, s55, 131072
  v_add_u32 v163, s55, v160
  v_lshrrev_b32 v2, 2, v160
  v_subrev_u32 v2, v160, v2
  v_add_u32 v3, v162, v2
  v_add_u32 v2, v163, v2
  s_lshl_b32 s55, s3, 2
  s_add_u32 s55, s55, 163104
  v_mov_b32 v100, s55
  v_mov_b32 v101, 1
  v_xor_b32 v102, 16, v100
  s_mov_b32 s69, 1904214016
  s_mov_b32 s63, 562036736
  s_mov_b32 s68, 1568669696
  v_exp_f32 v44, v44
  v_exp_f32 v45, v45
  v_exp_f32 v46, v46
  v_exp_f32 v47, v47
  v_exp_f32 v16, v16
  v_exp_f32 v17, v17
  v_smfmac_f32_32x32x32_bf16 v[128:143], v[148:151], v[40:47], v164
  v_exp_f32 v18, v18
  v_exp_f32 v19, v19
  v_exp_f32 v20, v20
  v_exp_f32 v21, v21
  s_waitcnt lgkmcnt(0)
  v_mfma_f32_32x32x16_bf16 v[32:47], v[84:87], v[12:15], 0
  v_exp_f32 v22, v22
  v_exp_f32 v23, v23
  v_exp_f32 v24, v24
  v_exp_f32 v25, v25
  v_exp_f32 v26, v26
  v_exp_f32 v27, v27
  v_smfmac_f32_32x32x32_bf16 v[112:127], v[152:155], v[16:23], v164
  v_exp_f32 v28, v28
  v_exp_f32 v29, v29
  v_exp_f32 v30, v30
  v_exp_f32 v31, v31
  v_exp_f32 v32, v32
  v_exp_f32 v33, v33
  v_smfmac_f32_32x32x32_bf16 v[112:127], v[156:159], v[24:31], v164
  v_exp_f32 v34, v34
  v_exp_f32 v35, v35
  v_exp_f32 v36, v36
  v_exp_f32 v37, v37
  v_exp_f32 v38, v38
  v_exp_f32 v39, v39
  v_exp_f32 v40, v40
  v_exp_f32 v41, v41
  v_exp_f32 v42, v42
  v_exp_f32 v43, v43
  v_smfmac_f32_32x32x32_bf16 v[128:143], v[152:155], v[32:39], v164
  v_exp_f32 v44, v44
  v_exp_f32 v45, v45
  v_exp_f32 v46, v46
  v_exp_f32 v47, v47
  s_cmp_eq_u32 s52, 0
  s_nop 0
  v_smfmac_f32_32x32x32_bf16 v[128:143], v[156:159], v[40:47], v164
  s_cbranch_scc1 L_x0
  ds_write_b128 v162, v[112:115]
  ds_write_b128 v162, v[116:119] offset:1024
  ds_write_b32 v3, v120 offset:2048
  ds_write_b32 v100, v101
  v_mov_b32 v8, v12
  v_mov_b32 v9, v13
  v_mov_b32 v10, v14
  v_mov_b32 v11, v15
  s_nop 2
  v_mov_b32 v112, v128
  v_mov_b32 v113, v129
  v_mov_b32 v114, v130
  v_mov_b32 v115, v131
  v_mov_b32 v116, v132
  v_mov_b32 v117, v133
  v_mov_b32 v118, v134
  v_mov_b32 v119, v135
  v_mov_b32 v120, v136
  s_branch L_x1
L_x0:
  s_nop 10
  ds_write_b128 v162, v[128:131]
  ds_write_b128 v162, v[132:135] offset:1024
  ds_write_b32 v3, v136 offset:2048
  ds_write_b32 v100, v101
L_x1:
  s_mov_b32 s49, 0
Lpg23:
  ds_read_b32 v101, v102
  ds_read_b128 v[16:19], v163
  ds_read_b128 v[20:23], v163 offset:1024
  ds_read_b32 v24, v2 offset:2048
  s_add_u32 s49, s49, 1
  s_waitcnt lgkmcnt(0)
  v_readfirstlane_b32 s50, v101
  s_cmp_gt_u32 s49, 1600000
  s_cbranch_scc1 Lpggo24
  s_cmp_eq_u32 s50, 0
  s_cbranch_scc1 Lpg23
Lpggo24:
  v_add_f32 v120, v120, v24
  v_pk_add_f32 v[112:113], v[112:113], v[16:17]
  v_pk_add_f32 v[114:115], v[114:115], v[18:19]
  v_pk_add_f32 v[116:117], v[116:117], v[20:21]
  v_pk_add_f32 v[118:119], v[118:119], v[22:23]
  v_cmp_ngt_f32 s[66:67], v120, s63
  v_cmp_nlt_f32 vcc, v120, s68
  v_add_f32 v162, abs(v112), abs(v113)
  v_add_f32 v163, abs(v114), abs(v115)
  v_add_f32 v2, abs(v116), abs(v117)
  v_add_f32 v3, abs(v118), abs(v119)
  v_add_f32 v162, v162, v163
  v_add_f32 v2, v2, v3
  s_or_b64 vcc, vcc, s[66:67]
  v_add_f32 v162, v162, v2
  v_cmp_nlt_f32 s[64:65], v162, s69
  s_or_b64 vcc, vcc, s[64:65]
  s_cbranch_vccnz L_slow
L_norm:
  v_rcp_f32 v162, v120
  s_nop 0
  v_mul_f32 v100, v162, v1
  v_pk_mul_f32 v[112:113], v[112:113], v[100:101] op_sel:[0,0] op_sel_hi:[1,0]
  v_pk_mul_f32 v[114:115], v[114:115], v[100:101] op_sel:[0,0] op_sel_hi:[1,0]
  v_pk_mul_f32 v[116:117], v[116:117], v[100:101] op_sel:[0,0] op_sel_hi:[1,0]
  v_pk_mul_f32 v[118:119], v[118:119], v[100:101] op_sel:[0,0] op_sel_hi:[1,0]
  v_cvt_pk_bf16_f32 v32, v112, v113
  v_cvt_pk_bf16_f32 v33, v114, v115
  v_cvt_pk_bf16_f32 v34, v116, v117
  v_cvt_pk_bf16_f32 v35, v118, v119
  v_min_u32 v32, -2, v32
  v_min_u32 v33, -2, v33
  v_min_u32 v34, -2, v34
  v_min_u32 v35, -2, v35
  buffer_store_dwordx4 v[32:35], v160, s[16:19], s61 offen sc1
  v_mov_b32 v162, 163088
  v_mov_b32 v163, 1
  s_mov_b64 exec, 1
  ds_add_u32 v162, v163
  s_mov_b64 exec, -1
  s_endpgm
L_slow:
  s_waitcnt vmcnt(0)
  v_mov_b32 v162, 0xff800000
  s_mov_b32 s54, 0
L_slow1:
  s_add_u32 s56, s57, s54
  buffer_load_dwordx4 v[80:83], v160, s[16:19], s56 offen sc1
  s_waitcnt vmcnt(0)
  v_mfma_f32_32x32x16_bf16 v[16:31], v[80:83], v[8:11], 0
  s_nop 15
  v_max3_f32 v162, v16, v17, v162
  v_max3_f32 v162, v18, v19, v162
  v_max3_f32 v162, v20, v21, v162
  v_max3_f32 v162, v22, v23, v162
  v_max3_f32 v162, v24, v25, v162
  v_max3_f32 v162, v26, v27, v162
  v_max3_f32 v162, v28, v29, v162
  v_max3_f32 v162, v30, v31, v162
  s_add_u32 s54, s54, 2048
  s_cmp_lt_u32 s54, 131072
  s_cbranch_scc1 L_slow1
  v_mov_b32 v163, v162
  s_nop 1
  v_permlane32_swap_b32 v162, v163
  s_nop 1
  v_max_f32 v162, v162, v163
  v_sub_f32 v162, 0, v162
  v_mov_b32 v48, v162
  v_mov_b32 v112, 0
  v_mov_b32 v49, v162
  v_mov_b32 v113, 0
  v_mov_b32 v50, v162
  v_mov_b32 v114, 0
  v_mov_b32 v51, v162
  v_mov_b32 v115, 0
  v_mov_b32 v52, v162
  v_mov_b32 v116, 0
  v_mov_b32 v53, v162
  v_mov_b32 v117, 0
  v_mov_b32 v54, v162
  v_mov_b32 v118, 0
  v_mov_b32 v55, v162
  v_mov_b32 v119, 0
  v_mov_b32 v56, v162
  v_mov_b32 v120, 0
  v_mov_b32 v57, v162
  v_mov_b32 v121, 0
  v_mov_b32 v58, v162
  v_mov_b32 v122, 0
  v_mov_b32 v59, v162
  v_mov_b32 v123, 0
  v_mov_b32 v60, v162
  v_mov_b32 v124, 0
  v_mov_b32 v61, v162
  v_mov_b32 v125, 0
  v_mov_b32 v62, v162
  v_mov_b32 v126, 0
  v_mov_b32 v63, v162
  v_mov_b32 v127, 0
  s_mov_b32 s54, 0
L_slow2:
  s_add_u32 s56, s57, s54
  buffer_load_dwordx4 v[80:83], v160, s[16:19], s56 offen sc1
  s_mov_b64 exec, s[58:59]
  buffer_load_dwordx4 v[144:147], v161, s[16:19], s56 offen offset:1024 sc1
  buffer_load_dwordx4 v[148:151], v161, s[16:19], s56 offen offset:1536 sc1
  s_mov_b64 exec, -1
  s_waitcnt vmcnt(0)
  v_mfma_f32_32x32x16_bf16 v[16:31], v[80:83], v[8:11], v[48:63]
  s_nop 15
  v_exp_f32 v16, v16
  v_exp_f32 v17, v17
  v_exp_f32 v18, v18
  v_exp_f32 v19, v19
  v_exp_f32 v20, v20
  v_exp_f32 v21, v21
  v_exp_f32 v22, v22
  v_exp_f32 v23, v23
  v_exp_f32 v24, v24
  v_exp_f32 v25, v25
  v_exp_f32 v26, v26
  v_exp_f32 v27, v27
  v_exp_f32 v28, v28
  v_exp_f32 v29, v29
  v_exp_f32 v30, v30
  v_exp_f32 v31, v31
  s_nop 1
  v_smfmac_f32_32x32x32_bf16 v[112:127], v[144:147], v[16:23], v164
  v_smfmac_f32_32x32x32_bf16 v[112:127], v[148:151], v[24:31], v164
  s_add_u32 s54, s54, 2048
  s_cmp_lt_u32 s54, 131072
  s_cbranch_scc1 L_slow2
  s_nop 15
  s_branch L_norm
L_swave:
  s_and_b32 s51, s3, 1
  s_bfe_u32 s52, s3, 0x10001
  s_and_b32 s55, s3, 3
  v_and_b32 v1, 31, v0
  v_lshrrev_b32 v2, 5, v0
  s_mov_b32 s18, 33554432
  s_mov_b32 s19, 0x20000
  s_mov_b32 s38, 524288
  s_mov_b32 s39, 0x20000
  s_mov_b32 s22, 4194304
  s_mov_b32 s23, 0x20000
  s_mov_b32 s34, 524288
  s_mov_b32 s35, 0x20000
  s_mov_b32 s42, 524288
  s_mov_b32 s43, 0x20000
  v_and_b32 v7, 0x13, v1
  v_and_b32 v3, 4, v1
  v_lshl_add_u32 v7, v3, 1, v7
  v_and_b32 v3, 8, v1
  v_lshrrev_b32 v3, 1, v3
  v_add_u32 v7, v7, v3
  s_lshl_b32 s53, s5, 6
  s_lshl_b32 s54, s52, 5
  s_add_u32 s53, s53, s54
  v_add_u32 v5, s53, v7
  v_lshlrev_b32 v5, 1, v5
  v_add_u32 v6, s53, v1
  v_lshlrev_b32 v6, 1, v6
  v_lshlrev_b32 v3, 4, v0
  s_waitcnt lgkmcnt(0)
  s_cmp_eq_u32 s52, 0
  s_cselect_b32 s32, s70, s72
  s_cselect_b32 s33, s71, s73
  s_mov_b32 s42, 1024
  s_setprio 3
  s_mov_b64 s[16:17], s[90:91]
  s_mov_b64 s[36:37], s[82:83]
  s_mov_b64 s[20:21], s[86:87]
  s_load_dword s6, s[16:17], 0
  s_mov_b32 s40, s84
  s_mov_b32 s41, s85
  buffer_load_dwordx4 v[72:75], v3, s[40:43], 0 offen
  s_mov_b32 s40, s62
  s_mov_b32 s41, s63
  buffer_load_ushort v8, v5, s[40:43], 0 offen
  s_mov_b32 s40, s64
  s_mov_b32 s41, s65
  buffer_load_ushort v9, v5, s[40:43], 0 offen
  s_mov_b32 s40, s74
  s_mov_b32 s41, s75
  buffer_load_ushort v10, v5, s[40:43], 0 offen
  s_mov_b32 s40, s76
  s_mov_b32 s41, s77
  buffer_load_ushort v160, v6, s[40:43], 0 offen
  s_setprio 0
  s_lshl_b32 s53, s5, 1
  s_add_u32 s53, s53, s52
  s_lshl_b32 s53, s53, 13
  s_add_u32 s53, s53, 262144
  s_add_u32 s44, s16, s53
  s_addc_u32 s45, s17, 0
  s_mov_b32 s46, 8192
  s_mov_b32 s47, 0x20000
  v_lshlrev_b32 v3, 2, v0
  v_add_u32 v3, 163072, v3
  v_mov_b32 v4, 0
  ds_write_b32 v3, v4
  v_add_u32 v7, s54, v7
  v_lshrrev_b32 v3, 1, v7
  v_and_b32 v3, 7, v3
  v_xor_b32 v3, v3, v2
  v_lshlrev_b32 v3, 4, v3
  v_lshlrev_b32 v4, 7, v7
  v_add_u32 v4, 65536, v4
  v_xor_b32 v24, 0, v3
  v_add_u32 v24, v24, v4
  v_xor_b32 v25, 32, v3
  v_add_u32 v25, v25, v4
  v_xor_b32 v26, 64, v3
  v_add_u32 v26, v26, v4
  v_xor_b32 v27, 96, v3
  v_add_u32 v27, v27, v4
  v_add_u32 v148, 65536, v24
  v_add_u32 v149, 65536, v25
  v_add_u32 v150, 65536, v26
  v_add_u32 v151, 65536, v27
  v_and_b32 v7, 3, v1
  v_lshrrev_b32 v3, 3, v1
  v_lshl_add_u32 v7, v3, 2, v7
  v_and_b32 v3, 4, v1
  v_lshl_add_u32 v7, v3, 2, v7
  s_lshl_b32 s54, s51, 5
  v_add_u32 v7, s54, v7
  v_lshrrev_b32 v3, 1, v7
  v_and_b32 v3, 7, v3
  v_xor_b32 v3, v3, v2
  v_lshlrev_b32 v3, 4, v3
  v_lshlrev_b32 v4, 7, v7
  v_xor_b32 v20, 0, v3
  v_add_u32 v20, v20, v4
  v_xor_b32 v21, 32, v3
  v_add_u32 v21, v21, v4
  v_xor_b32 v22, 64, v3
  v_add_u32 v22, v22, v4
  v_xor_b32 v23, 96, v3
  v_add_u32 v23, v23, v4
  s_lshl_b32 s56, s55, 5
  v_lshrrev_b32 v3, 1, v0
  v_and_b32 v3, 7, v3
  v_lshlrev_b32 v3, 4, v3
  v_lshl_add_u32 v3, v0, 7, v3
  v_xor_b32 v162, s56, v3
  v_xor_b32 v163, 16, v162
  v_mov_b32 v164, 0
  v_mov_b32 v165, 0
  v_mov_b32 v30, 0
  v_mov_b32 v31, 0
  s_add_u32 s56, s56, 159744
  v_mov_b32 v161, s56
  v_lshrrev_b32 v5, 3, v0
  v_subrev_u32 v5, s7, v5
  v_and_b32 v5, 7, v5
  v_lshlrev_b32 v5, 7, v5
  v_and_b32 v6, 7, v0
  v_lshl_add_u32 v5, v6, 4, v5
  v_add_u32 v76, 159744, v5
  s_barrier
  s_waitcnt vmcnt(0)
  ds_write_b128 v76, v[72:75]
  v_lshlrev_b32 v8, 16, v8
  v_lshlrev_b32 v9, 16, v9
  v_lshlrev_b32 v10, 16, v10
  v_lshlrev_b32 v160, 16, v160
  v_mul_f32 v10, 1069066811, v10
  v_exp_f32 v10, v10
  v_mul_f32 v14, v8, v8
  v_cvt_pk_bf16_f32 v10, v10, v10
  v_fmac_f32 v14, v9, v9
  v_and_b32 v10, 0xffff0000, v10
  v_rcp_f32 v14, v14
  s_barrier
  ds_read_b128 v[32:35], v162 offset:0
  ds_read_b128 v[40:43], v161 offset:0
  ds_read_b128 v[36:39], v163 offset:0
  ds_read_b128 v[44:47], v161 offset:16
  v_mul_f32 v76, v10, v8
  v_mul_f32 v77, v10, v9
  v_mul_f32 v76, 1069066811, v76
  v_mul_f32 v77, 1042479491, v77
  v_exp_f32 v76, v76
  v_rndne_f32 v78, v77
  v_sub_f32 v77, v77, v78
  v_cos_f32 v78, v77
  v_sin_f32 v79, v77
  s_waitcnt lgkmcnt(0)
  v_dot2c_f32_bf16 v164, v40, v32
  v_dot2c_f32_bf16 v165, v41, v33
  v_dot2c_f32_bf16 v30, v42, v34
  v_dot2c_f32_bf16 v31, v43, v35
  v_dot2c_f32_bf16 v164, v44, v36
  v_dot2c_f32_bf16 v165, v45, v37
  v_dot2c_f32_bf16 v30, v46, v38
  v_dot2c_f32_bf16 v31, v47, v39
  s_waitcnt lgkmcnt(0)
  s_barrier
  ds_read_b128 v[32:35], v162 offset:8192
  ds_read_b128 v[40:43], v161 offset:128
  ds_read_b128 v[36:39], v163 offset:8192
  ds_read_b128 v[44:47], v161 offset:144
  v_add_f32 v14, v14, v14
  v_mul_f32 v78, v76, v78
  v_mul_f32 v79, v76, v79
  v_add_f32 v76, -1.0, v78
  v_mul_f32 v10, v76, v8
  v_mul_f32 v11, v79, v8
  v_fmac_f32 v10, v79, v9
  v_fma_f32 v11, -v76, v9, v11
  v_mul_f32 v10, v10, v14
  v_mul_f32 v11, v11, v14
  v_mov_b32 v8, v78
  v_mov_b32 v9, v79
  s_waitcnt lgkmcnt(0)
  v_dot2c_f32_bf16 v164, v40, v32
  v_dot2c_f32_bf16 v165, v41, v33
  v_dot2c_f32_bf16 v30, v42, v34
  v_dot2c_f32_bf16 v31, v43, v35
  v_dot2c_f32_bf16 v164, v44, v36
  v_dot2c_f32_bf16 v165, v45, v37
  v_dot2c_f32_bf16 v30, v46, v38
  v_dot2c_f32_bf16 v31, v47, v39
  s_mul_i32 s6, s6, 0x9E3779B1
  s_add_u32 s6, s6, 0x7F4A7C15
  s_waitcnt lgkmcnt(0)
  s_barrier
  ds_read_b128 v[32:35], v162 offset:16384
  ds_read_b128 v[40:43], v161 offset:256
  ds_read_b128 v[36:39], v163 offset:16384
  ds_read_b128 v[44:47], v161 offset:272
  v_mul_f32 v3, v9, v9
  v_mul_f32 v4, v8, v9
  v_fma_f32 v12, v8, v8, -v3
  v_add_f32 v13, v4, v4
  v_mul_f32 v3, v13, v13
  v_mul_f32 v4, v12, v13
  v_fma_f32 v12, v12, v12, -v3
  v_add_f32 v13, v4, v4
  s_waitcnt lgkmcnt(0)
  v_dot2c_f32_bf16 v164, v40, v32
  v_dot2c_f32_bf16 v165, v41, v33
  v_dot2c_f32_bf16 v30, v42, v34
  v_dot2c_f32_bf16 v31, v43, v35
  v_dot2c_f32_bf16 v164, v44, v36
  v_dot2c_f32_bf16 v165, v45, v37
  v_dot2c_f32_bf16 v30, v46, v38
  v_dot2c_f32_bf16 v31, v47, v39
  s_waitcnt lgkmcnt(0)
  s_barrier
  ds_read_b128 v[112:115], v20 offset:0
  ds_read_b128 v[116:119], v24 offset:49152
  ds_read_b128 v[120:123], v24 offset:57344
  ds_read_b128 v[124:127], v21 offset:0
  ds_read_b128 v[128:131], v25 offset:49152
  ds_read_b128 v[132:135], v25 offset:57344
  ds_read_b128 v[136:139], v22 offset:0
  ds_read_b128 v[140:143], v26 offset:49152
  ds_read_b128 v[144:147], v26 offset:57344
  s_waitcnt lgkmcnt(6)
  v_mfma_f32_32x32x16_bf16 v[80:95], v[112:115], v[116:119], 0
  v_mfma_f32_32x32x16_bf16 v[96:111], v[112:115], v[120:123], 0
  ds_read_b128 v[112:115], v23 offset:0
  ds_read_b128 v[116:119], v27 offset:49152
  ds_read_b128 v[120:123], v27 offset:57344
  s_waitcnt lgkmcnt(6)
  v_mfma_f32_32x32x16_bf16 v[80:95], v[124:127], v[128:131], v[80:95]
  v_mfma_f32_32x32x16_bf16 v[96:111], v[124:127], v[132:135], v[96:111]
  s_waitcnt lgkmcnt(0)
  s_barrier
  ds_read_b128 v[32:35], v162 offset:24576
  ds_read_b128 v[40:43], v161 offset:384
  ds_read_b128 v[36:39], v163 offset:24576
  ds_read_b128 v[44:47], v161 offset:400
  ds_read_b128 v[48:51], v162 offset:32768
  ds_read_b128 v[56:59], v161 offset:512
  ds_read_b128 v[52:55], v163 offset:32768
  ds_read_b128 v[60:63], v161 offset:528
  v_mul_f32 v3, v13, v13
  v_mul_f32 v4, v12, v13
  v_fma_f32 v12, v12, v12, -v3
  v_add_f32 v13, v4, v4
  v_mul_f32 v3, v13, v13
  v_mul_f32 v4, v12, v13
  v_fma_f32 v12, v12, v12, -v3
  v_add_f32 v13, v4, v4
  s_waitcnt lgkmcnt(0)
  v_dot2c_f32_bf16 v164, v40, v32
  v_dot2c_f32_bf16 v165, v41, v33
  v_dot2c_f32_bf16 v30, v42, v34
  v_dot2c_f32_bf16 v31, v43, v35
  v_dot2c_f32_bf16 v164, v44, v36
  v_dot2c_f32_bf16 v165, v45, v37
  v_dot2c_f32_bf16 v30, v46, v38
  v_dot2c_f32_bf16 v31, v47, v39
  v_dot2c_f32_bf16 v164, v56, v48
  v_dot2c_f32_bf16 v165, v57, v49
  v_dot2c_f32_bf16 v30, v58, v50
  v_dot2c_f32_bf16 v31, v59, v51
  v_dot2c_f32_bf16 v164, v60, v52
  v_dot2c_f32_bf16 v165, v61, v53
  v_dot2c_f32_bf16 v30, v62, v54
  v_dot2c_f32_bf16 v31, v63, v55
  s_waitcnt lgkmcnt(0)
  s_barrier
  ds_read_b128 v[32:35], v162 offset:40960
  ds_read_b128 v[40:43], v161 offset:640
  ds_read_b128 v[36:39], v163 offset:40960
  ds_read_b128 v[44:47], v161 offset:656
  v_mul_f32 v3, v13, v13
  v_mul_f32 v4, v12, v13
  v_fma_f32 v14, v12, v12, -v3
  v_add_f32 v15, v4, v4
  v_mul_f32 v3, v15, v15
  v_mul_f32 v4, v14, v15
  v_fma_f32 v16, v14, v14, -v3
  v_add_f32 v17, v4, v4
  v_mul_f32 v3, v17, v17
  v_mul_f32 v4, v16, v17
  v_fma_f32 v18, v16, v16, -v3
  v_add_f32 v19, v4, v4
  s_sub_u32 s53, s5, s7
  s_and_b32 s53, s53, 7
  s_lshl_b32 s53, s53, 13
  s_lshl_b32 s54, s51, 12
  s_add_u32 s53, s53, s54
  s_lshl_b32 s54, s52, 6
  s_add_u32 s53, s53, s54
  v_lshlrev_b32 v28, 11, v2
  v_lshrrev_b32 v4, 3, v1
  v_lshl_add_u32 v28, v4, 4, v28
  v_and_b32 v4, 7, v1
  v_lshl_add_u32 v28, v4, 1, v28
  v_add_u32 v28, s53, v28
  s_lshl_b32 s54, s51, 7
  s_add_u32 s54, s54, 162816
  v_lshlrev_b32 v29, 6, v2
  v_add_u32 v29, s54, v29
  s_waitcnt lgkmcnt(0)
  v_dot2c_f32_bf16 v164, v40, v32
  v_dot2c_f32_bf16 v165, v41, v33
  v_dot2c_f32_bf16 v30, v42, v34
  v_dot2c_f32_bf16 v31, v43, v35
  v_dot2c_f32_bf16 v164, v44, v36
  v_dot2c_f32_bf16 v165, v45, v37
  v_dot2c_f32_bf16 v30, v46, v38
  v_dot2c_f32_bf16 v31, v47, v39
  s_waitcnt lgkmcnt(0)
  s_barrier
  ds_read_b128 v[32:35], v162 offset:49152
  ds_read_b128 v[40:43], v161 offset:768
  ds_read_b128 v[36:39], v163 offset:49152
  ds_read_b128 v[44:47], v161 offset:784
  ds_read_b128 v[48:51], v162 offset:57344
  ds_read_b128 v[56:59], v161 offset:896
  ds_read_b128 v[52:55], v163 offset:57344
  ds_read_b128 v[60:63], v161 offset:912
  s_waitcnt lgkmcnt(0)
  v_dot2c_f32_bf16 v164, v40, v32
  v_dot2c_f32_bf16 v165, v41, v33
  v_dot2c_f32_bf16 v30, v42, v34
  v_dot2c_f32_bf16 v31, v43, v35
  v_dot2c_f32_bf16 v164, v44, v36
  v_dot2c_f32_bf16 v165, v45, v37
  v_dot2c_f32_bf16 v30, v46, v38
  v_dot2c_f32_bf16 v31, v47, v39
  v_dot2c_f32_bf16 v164, v56, v48
  v_dot2c_f32_bf16 v165, v57, v49
  v_dot2c_f32_bf16 v30, v58, v50
  v_dot2c_f32_bf16 v31, v59, v51
  v_dot2c_f32_bf16 v164, v60, v52
  v_dot2c_f32_bf16 v165, v61, v53
  v_dot2c_f32_bf16 v30, v62, v54
  v_dot2c_f32_bf16 v31, v63, v55
  s_lshl_b32 s56, s55, 8
  s_add_u32 s56, s56, 161792
  v_lshlrev_b32 v3, 2, v0
  v_add_u32 v4, s56, v3
  s_nop 1
  v_add_f32 v164, v164, v165
  v_add_f32 v30, v30, v31
  v_add_f32 v164, v164, v30
  ds_write_b32 v4, v164
  ds_read_b128 v[124:127], v20 offset:8192
  ds_read_b128 v[128:131], v24 offset:0
  ds_read_b128 v[132:135], v24 offset:8192
  v_mfma_f32_32x32x16_bf16 v[80:95], v[136:139], v[140:143], v[80:95]
  v_mfma_f32_32x32x16_bf16 v[96:111], v[136:139], v[144:147], v[96:111]
  ds_read_b128 v[136:139], v21 offset:8192
  ds_read_b128 v[140:143], v25 offset:0
  ds_read_b128 v[144:147], v25 offset:8192
  v_mfma_f32_32x32x16_bf16 v[80:95], v[112:115], v[116:119], v[80:95]
  v_mfma_f32_32x32x16_bf16 v[96:111], v[112:115], v[120:123], v[96:111]
  ds_read_b128 v[112:115], v22 offset:8192
  ds_read_b128 v[116:119], v26 offset:0
  ds_read_b128 v[120:123], v26 offset:8192
  s_waitcnt lgkmcnt(6)
  v_mfma_f32_32x32x16_bf16 v[80:95], v[124:127], v[128:131], v[80:95]
  v_mfma_f32_32x32x16_bf16 v[96:111], v[124:127], v[132:135], v[96:111]
  ds_read_b128 v[124:127], v23 offset:8192
  ds_read_b128 v[128:131], v27 offset:0
  ds_read_b128 v[132:135], v27 offset:8192
  s_waitcnt lgkmcnt(6)
  v_mfma_f32_32x32x16_bf16 v[80:95], v[136:139], v[140:143], v[80:95]
  v_mfma_f32_32x32x16_bf16 v[96:111], v[136:139], v[144:147], v[96:111]
  s_waitcnt lgkmcnt(0)
  s_barrier
  ds_read_b128 v[136:139], v20 offset:16384
  ds_read_b128 v[140:143], v24 offset:24576
  ds_read_b128 v[144:147], v24 offset:16384
  v_mfma_f32_32x32x16_bf16 v[80:95], v[112:115], v[116:119], v[80:95]
  v_mfma_f32_32x32x16_bf16 v[96:111], v[112:115], v[120:123], v[96:111]
  ds_read_b128 v[112:115], v21 offset:16384
  ds_read_b128 v[116:119], v25 offset:24576
  ds_read_b128 v[120:123], v25 offset:16384
  v_mfma_f32_32x32x16_bf16 v[80:95], v[124:127], v[128:131], v[80:95]
  v_mfma_f32_32x32x16_bf16 v[96:111], v[124:127], v[132:135], v[96:111]
  ds_read_b128 v[124:127], v22 offset:16384
  ds_read_b128 v[128:131], v26 offset:24576
  ds_read_b128 v[132:135], v26 offset:16384
  s_waitcnt lgkmcnt(6)
  v_mfma_f32_32x32x16_bf16 v[80:95], v[136:139], v[140:143], v[80:95]
  v_mfma_f32_32x32x16_bf16 v[96:111], v[136:139], v[144:147], v[96:111]
  ds_read_b128 v[136:139], v23 offset:16384
  ds_read_b128 v[140:143], v27 offset:24576
  ds_read_b128 v[144:147], v27 offset:16384
  s_waitcnt lgkmcnt(6)
  v_mfma_f32_32x32x16_bf16 v[80:95], v[112:115], v[116:119], v[80:95]
  v_mfma_f32_32x32x16_bf16 v[96:111], v[112:115], v[120:123], v[96:111]
  s_lshl_b32 s56, s51, 1
  v_lshrrev_b32 v3, 3, v0
  v_and_b32 v4, 7, v0
  s_lshl_b32 s48, s56, 4
  v_add_u32 v5, s48, v3
  v_lshlrev_b32 v162, 10, v5
  v_mul_u32_u24 v72, 1024, v5
  v_lshrrev_b32 v3, 1, v3
  v_xor_b32 v5, v4, v3
  v_lshl_add_u32 v162, v5, 4, v162
  v_xor_b32 v163, 64, v162
  v_add_u32 v163, 8192, v163
  v_and_b32 v3, 1, v3
  v_lshlrev_b32 v3, 2, v3
  v_xor_b32 v5, v4, v3
  v_lshl_add_u32 v72, v5, 4, v72
  v_lshrrev_b32 v3, 3, v0
  v_and_b32 v4, 7, v0
  s_lshl_b32 s48, s55, 4
  v_add_u32 v5, s48, v3
  v_lshlrev_b32 v72, 10, v5
  v_mul_u32_u24 v164, 1024, v5
  v_lshrrev_b32 v3, 1, v3
  v_xor_b32 v5, v4, v3
  v_lshl_add_u32 v72, v5, 4, v72
  v_xor_b32 v73, 64, v72
  v_add_u32 v73, 8192, v73
  v_and_b32 v3, 1, v3
  v_lshlrev_b32 v3, 2, v3
  v_xor_b32 v5, v4, v3
  v_lshl_add_u32 v164, v5, 4, v164
  v_lshrrev_b32 v3, 1, v1
  v_and_b32 v3, 7, v3
  v_xor_b32 v3, v3, v2
  v_lshlrev_b32 v3, 4, v3
  v_lshlrev_b32 v4, 7, v1
  v_xor_b32 v152, 0, v3
  v_add_u32 v152, v152, v4
  v_xor_b32 v153, 32, v3
  v_add_u32 v153, v153, v4
  v_xor_b32 v154, 64, v3
  v_add_u32 v154, v154, v4
  v_xor_b32 v155, 96, v3
  v_add_u32 v155, v155, v4
  s_lshl_b32 s56, s52, 15
  s_lshl_b32 s57, s52, 12
  s_add_u32 s56, s56, s57
  v_add_u32 v152, s56, v152
  v_xor_b32 v156, 4096, v152
  v_add_u32 v153, s56, v153
  v_xor_b32 v157, 4096, v153
  v_add_u32 v154, s56, v154
  v_xor_b32 v158, 4096, v154
  v_add_u32 v155, s56, v155
  v_xor_b32 v159, 4096, v155
  v_mov_b32 v32, 0
  v_mov_b32 v33, 0
  v_mov_b32 v34, 0
  v_mov_b32 v35, 0
  v_mov_b32 v36, 0
  v_mov_b32 v37, 0
  v_mov_b32 v38, 0
  v_mov_b32 v39, 0
  v_mov_b32 v40, 0
  v_mov_b32 v41, 0
  v_mov_b32 v42, 0
  v_mov_b32 v43, 0
  v_mov_b32 v44, 0
  v_mov_b32 v45, 0
  v_mov_b32 v46, 0
  v_mov_b32 v47, 0
  v_xor_b32 v4, 0, v28
  ds_read_u16_d16_hi v32, v4 offset:0
  ds_read_u16_d16_hi v33, v4 offset:128
  v_xor_b32 v4, 16, v28
  ds_read_u16_d16_hi v34, v4 offset:256
  ds_read_u16_d16_hi v35, v4 offset:384
  v_xor_b32 v4, 32, v28
  ds_read_u16_d16_hi v36, v4 offset:512
  ds_read_u16_d16_hi v37, v4 offset:640
  v_xor_b32 v4, 48, v28
  ds_read_u16_d16_hi v38, v4 offset:768
  ds_read_u16_d16_hi v39, v4 offset:896
  v_xor_b32 v4, 64, v28
  ds_read_u16_d16_hi v40, v4 offset:1024
  ds_read_u16_d16_hi v41, v4 offset:1152
  v_xor_b32 v4, 80, v28
  ds_read_u16_d16_hi v42, v4 offset:1280
  ds_read_u16_d16_hi v43, v4 offset:1408
  v_xor_b32 v4, 96, v28
  ds_read_u16_d16_hi v44, v4 offset:1536
  ds_read_u16_d16_hi v45, v4 offset:1664
  v_xor_b32 v4, 112, v28
  ds_read_u16_d16_hi v46, v4 offset:1792
  ds_read_u16_d16_hi v47, v4 offset:1920
  s_waitcnt lgkmcnt(0)
  s_barrier
  ds_read_b128 v[112:115], v20 offset:24576
  ds_read_b128 v[116:119], v148 offset:8192
  ds_read_b128 v[120:123], v24 offset:8192
  v_mfma_f32_32x32x16_bf16 v[80:95], v[124:127], v[128:131], v[80:95]
  v_mfma_f32_32x32x16_bf16 v[96:111], v[124:127], v[132:135], v[96:111]
  ds_read_b128 v[124:127], v21 offset:24576
  ds_read_b128 v[128:131], v149 offset:8192
  ds_read_b128 v[132:135], v25 offset:8192
  v_mfma_f32_32x32x16_bf16 v[80:95], v[136:139], v[140:143], v[80:95]
  v_mfma_f32_32x32x16_bf16 v[96:111], v[136:139], v[144:147], v[96:111]
  ds_read_b128 v[136:139], v22 offset:24576
  ds_read_b128 v[140:143], v150 offset:8192
  ds_read_b128 v[144:147], v26 offset:8192
  s_waitcnt lgkmcnt(6)
  v_mfma_f32_32x32x16_bf16 v[80:95], v[112:115], v[116:119], v[80:95]
  v_mfma_f32_32x32x16_bf16 v[96:111], v[112:115], v[120:123], v[96:111]
  ds_read_b128 v[112:115], v23 offset:24576
  ds_read_b128 v[116:119], v151 offset:8192
  ds_read_b128 v[120:123], v27 offset:8192
  s_waitcnt lgkmcnt(6)
  v_mfma_f32_32x32x16_bf16 v[80:95], v[124:127], v[128:131], v[80:95]
  v_mfma_f32_32x32x16_bf16 v[96:111], v[124:127], v[132:135], v[96:111]
  s_waitcnt lgkmcnt(0)
  s_barrier
  ds_read_b128 v[48:51], v29 offset:0
  ds_read_b128 v[52:55], v29 offset:16
  ds_read_b128 v[56:59], v29 offset:32
  ds_read_b128 v[60:63], v29 offset:48
  v_pk_mul_f32 v[32:33], v[32:33], v[160:161] op_sel:[0,0] op_sel_hi:[1,0]
  v_pk_mul_f32 v[34:35], v[34:35], v[160:161] op_sel:[0,0] op_sel_hi:[1,0]
  v_pk_mul_f32 v[36:37], v[36:37], v[160:161] op_sel:[0,0] op_sel_hi:[1,0]
  v_pk_mul_f32 v[38:39], v[38:39], v[160:161] op_sel:[0,0] op_sel_hi:[1,0]
  v_pk_mul_f32 v[40:41], v[40:41], v[160:161] op_sel:[0,0] op_sel_hi:[1,0]
  v_pk_mul_f32 v[42:43], v[42:43], v[160:161] op_sel:[0,0] op_sel_hi:[1,0]
  v_pk_mul_f32 v[44:45], v[44:45], v[160:161] op_sel:[0,0] op_sel_hi:[1,0]
  v_pk_mul_f32 v[46:47], v[46:47], v[160:161] op_sel:[0,0] op_sel_hi:[1,0]
  s_waitcnt lgkmcnt(0)
  s_barrier
  ds_read_b128 v[124:127], v20 offset:32768
  ds_read_b128 v[128:131], v24 offset:49152
  ds_read_b128 v[132:135], v24 offset:40960
  v_mfma_f32_32x32x16_bf16 v[80:95], v[136:139], v[140:143], v[80:95]
  v_mfma_f32_32x32x16_bf16 v[96:111], v[136:139], v[144:147], v[96:111]
  ds_read_b128 v[136:139], v21 offset:32768
  ds_read_b128 v[140:143], v25 offset:49152
  ds_read_b128 v[144:147], v25 offset:40960
  v_mfma_f32_32x32x16_bf16 v[80:95], v[112:115], v[116:119], v[80:95]
  v_mfma_f32_32x32x16_bf16 v[96:111], v[112:115], v[120:123], v[96:111]
  ds_read_b128 v[112:115], v22 offset:32768
  ds_read_b128 v[116:119], v26 offset:49152
  ds_read_b128 v[120:123], v26 offset:40960
  s_waitcnt lgkmcnt(6)
  v_mfma_f32_32x32x16_bf16 v[80:95], v[124:127], v[128:131], v[80:95]
  v_mfma_f32_32x32x16_bf16 v[96:111], v[124:127], v[132:135], v[96:111]
  ds_read_b128 v[124:127], v23 offset:32768
  ds_read_b128 v[128:131], v27 offset:49152
  ds_read_b128 v[132:135], v27 offset:40960
  s_waitcnt lgkmcnt(6)
  v_mfma_f32_32x32x16_bf16 v[80:95], v[136:139], v[140:143], v[80:95]
  v_mfma_f32_32x32x16_bf16 v[96:111], v[136:139], v[144:147], v[96:111]
  ds_read_b128 v[136:139], v20 offset:40960
  ds_read_b128 v[140:143], v24 offset:24576
  ds_read_b128 v[144:147], v24 offset:16384
  s_waitcnt lgkmcnt(6)
  v_mfma_f32_32x32x16_bf16 v[80:95], v[112:115], v[116:119], v[80:95]
  v_mfma_f32_32x32x16_bf16 v[96:111], v[112:115], v[120:123], v[96:111]
  ds_read_b128 v[112:115], v21 offset:40960
  ds_read_b128 v[116:119], v25 offset:24576
  ds_read_b128 v[120:123], v25 offset:16384
  s_waitcnt lgkmcnt(6)
  v_mfma_f32_32x32x16_bf16 v[80:95], v[124:127], v[128:131], v[80:95]
  v_mfma_f32_32x32x16_bf16 v[96:111], v[124:127], v[132:135], v[96:111]
  ds_read_b128 v[124:127], v22 offset:40960
  ds_read_b128 v[128:131], v26 offset:24576
  ds_read_b128 v[132:135], v26 offset:16384
  s_waitcnt lgkmcnt(6)
  v_mfma_f32_32x32x16_bf16 v[80:95], v[136:139], v[140:143], v[80:95]
  v_mfma_f32_32x32x16_bf16 v[96:111], v[136:139], v[144:147], v[96:111]
  ds_read_b128 v[136:139], v23 offset:40960
  ds_read_b128 v[140:143], v27 offset:24576
  ds_read_b128 v[144:147], v27 offset:16384
  s_waitcnt lgkmcnt(6)
  v_mfma_f32_32x32x16_bf16 v[80:95], v[112:115], v[116:119], v[80:95]
  v_mfma_f32_32x32x16_bf16 v[96:111], v[112:115], v[120:123], v[96:111]
  v_pk_mul_f32 v[32:33], v[32:33], v[48:49]
  v_pk_mul_f32 v[34:35], v[34:35], v[50:51]
  v_pk_mul_f32 v[36:37], v[36:37], v[52:53]
  v_pk_mul_f32 v[38:39], v[38:39], v[54:55]
  v_pk_mul_f32 v[40:41], v[40:41], v[56:57]
  v_pk_mul_f32 v[42:43], v[42:43], v[58:59]
  v_pk_mul_f32 v[44:45], v[44:45], v[60:61]
  v_pk_mul_f32 v[46:47], v[46:47], v[62:63]
  v_bfe_u32 v3, v1, 2, 1
  v_xor_b32 v3, v3, v2
  v_lshlrev_b32 v3, 3, v3
  v_bfe_u32 v4, v1, 4, 1
  v_lshl_add_u32 v3, v4, 2, v3
  v_bfe_u32 v4, v1, 3, 1
  v_lshl_add_u32 v3, v4, 1, v3
  v_bfe_u32 v4, v1, 1, 1
  v_add_u32 v3, v3, v4
  v_and_b32 v4, 1, v1
  v_lshlrev_b32 v4, 4, v4
  v_mov_b32 v5, 0x3f80
  v_lshlrev_b32 v4, v4, v5
  v_cmp_eq_u32 s[60:61], 0, v3
  v_cmp_eq_u32 s[62:63], 1, v3
  v_cmp_eq_u32 s[64:65], 2, v3
  v_cmp_eq_u32 s[66:67], 3, v3
  v_cmp_eq_u32 s[68:69], 4, v3
  v_cmp_eq_u32 s[70:71], 5, v3
  v_cmp_eq_u32 s[72:73], 6, v3
  v_cmp_eq_u32 s[74:75], 7, v3
  v_cndmask_b32 v64, 0, v4, s[60:61]
  v_cndmask_b32 v65, 0, v4, s[62:63]
  v_cndmask_b32 v66, 0, v4, s[64:65]
  v_cndmask_b32 v67, 0, v4, s[66:67]
  v_cndmask_b32 v68, 0, v4, s[68:69]
  v_cndmask_b32 v69, 0, v4, s[70:71]
  v_cndmask_b32 v70, 0, v4, s[72:73]
  v_cndmask_b32 v71, 0, v4, s[74:75]
  v_bfe_u32 v3, v0, 2, 2
  v_lshrrev_b32 v4, 5, v0
  v_mul_u32_u24 v4, 4, v4
  v_add_u32 v4, v4, v3
  v_lshlrev_b32 v165, 7, v4
  v_bfe_u32 v4, v0, 4, 1
  v_lshlrev_b32 v4, 1, v4
  v_bfe_u32 v5, v0, 1, 1
  v_add_u32 v4, v4, v5
  v_mov_b32 v5, s52
  v_lshl_add_u32 v4, v5, 2, v4
  v_lshrrev_b32 v3, 1, v3
  v_lshlrev_b32 v3, 2, v3
  v_xor_b32 v4, v4, v3
  v_lshl_add_u32 v165, v4, 4, v165
  v_and_b32 v3, 1, v0
  v_lshl_add_u32 v165, v3, 3, v165
  s_lshl_b32 s56, s52, 15
  v_add_u32 v165, s56, v165
  v_xor_b32 v161, 64, v165
  s_lshl_b32 s56, s4, 1
  s_add_u32 s56, s56, s51
  s_lshl_b32 s56, s56, 16
  s_lshl_b32 s57, s5, 8
  s_add_u32 s56, s56, s57
  s_lshl_b32 s57, s52, 7
  s_add_u32 s56, s56, s57
  v_lshlrev_b32 v30, 15, v2
  v_lshl_add_u32 v30, v1, 2, v30
  v_add_u32 v30, s56, v30
  s_lshl_b32 s56, s55, 12
  s_add_u32 s56, s56, 131072
  v_lshlrev_b32 v31, 4, v0
  v_add_u32 v31, s56, v31
  s_waitcnt lgkmcnt(0)
  s_barrier
  ds_read_b128 v[112:115], v20 offset:49152
  ds_read_b128 v[116:119], v24 offset:32768
  ds_read_b128 v[120:123], v24 offset:8192
  v_mfma_f32_32x32x16_bf16 v[80:95], v[124:127], v[128:131], v[80:95]
  v_mfma_f32_32x32x16_bf16 v[96:111], v[124:127], v[132:135], v[96:111]
  ds_read_b128 v[124:127], v21 offset:49152
  ds_read_b128 v[128:131], v25 offset:32768
  ds_read_b128 v[132:135], v25 offset:8192
  v_mfma_f32_32x32x16_bf16 v[80:95], v[136:139], v[140:143], v[80:95]
  v_mfma_f32_32x32x16_bf16 v[96:111], v[136:139], v[144:147], v[96:111]
  ds_read_b128 v[136:139], v22 offset:49152
  ds_read_b128 v[140:143], v26 offset:32768
  ds_read_b128 v[144:147], v26 offset:8192
  s_waitcnt lgkmcnt(6)
  v_mfma_f32_32x32x16_bf16 v[80:95], v[112:115], v[116:119], v[80:95]
  v_mfma_f32_32x32x16_bf16 v[96:111], v[112:115], v[120:123], v[96:111]
  ds_read_b128 v[112:115], v23 offset:49152
  ds_read_b128 v[116:119], v27 offset:32768
  ds_read_b128 v[120:123], v27 offset:8192
  s_waitcnt lgkmcnt(6)
  v_mfma_f32_32x32x16_bf16 v[80:95], v[124:127], v[128:131], v[80:95]
  v_mfma_f32_32x32x16_bf16 v[96:111], v[124:127], v[132:135], v[96:111]
  ds_read_b128 v[124:127], v20 offset:57344
  ds_read_b128 v[128:131], v24 offset:57344
  ds_read_b128 v[132:135], v24 offset:0
  s_waitcnt lgkmcnt(6)
  v_mfma_f32_32x32x16_bf16 v[80:95], v[136:139], v[140:143], v[80:95]
  v_mfma_f32_32x32x16_bf16 v[96:111], v[136:139], v[144:147], v[96:111]
  ds_read_b128 v[136:139], v21 offset:57344
  ds_read_b128 v[140:143], v25 offset:57344
  ds_read_b128 v[144:147], v25 offset:0
  s_waitcnt lgkmcnt(6)
  v_mfma_f32_32x32x16_bf16 v[80:95], v[112:115], v[116:119], v[80:95]
  v_mfma_f32_32x32x16_bf16 v[96:111], v[112:115], v[120:123], v[96:111]
  ds_read_b128 v[112:115], v22 offset:57344
  ds_read_b128 v[116:119], v26 offset:57344
  ds_read_b128 v[120:123], v26 offset:0
  s_waitcnt lgkmcnt(6)
  v_mfma_f32_32x32x16_bf16 v[80:95], v[124:127], v[128:131], v[80:95]
  v_mfma_f32_32x32x16_bf16 v[96:111], v[124:127], v[132:135], v[96:111]
  ds_read_b128 v[124:127], v23 offset:57344
  ds_read_b128 v[128:131], v27 offset:57344
  ds_read_b128 v[132:135], v27 offset:0
  s_waitcnt lgkmcnt(6)
  v_mfma_f32_32x32x16_bf16 v[80:95], v[136:139], v[140:143], v[80:95]
  v_mfma_f32_32x32x16_bf16 v[96:111], v[136:139], v[144:147], v[96:111]
  s_waitcnt lgkmcnt(3)
  v_mfma_f32_32x32x16_bf16 v[80:95], v[112:115], v[116:119], v[80:95]
  v_mfma_f32_32x32x16_bf16 v[96:111], v[112:115], v[120:123], v[96:111]
  s_waitcnt lgkmcnt(0)
  v_mfma_f32_32x32x16_bf16 v[80:95], v[124:127], v[128:131], v[80:95]
  v_mfma_f32_32x32x16_bf16 v[96:111], v[124:127], v[132:135], v[96:111]
  s_setprio 3
  v_mov_b32 v3, 163084
  v_mov_b32 v4, 1
  s_mov_b64 exec, 1
  ds_add_u32 v3, v4
  s_mov_b64 exec, -1
  s_nop 4
  v_fma_f32 v74, v8, v80, v81
  v_fma_f32 v75, v8, v96, v97
  v_fma_f32 v74, -v9, v96, v74
  v_fma_f32 v75, v9, v80, v75
  v_fma_f32 v72, v8, v74, v82
  v_fma_f32 v73, v8, v75, v98
  v_fma_f32 v72, -v9, v75, v72
  v_fma_f32 v73, v9, v74, v73
  v_fma_f32 v74, v8, v72, v83
  v_fma_f32 v75, v8, v73, v99
  v_fma_f32 v74, -v9, v73, v74
  v_fma_f32 v75, v9, v72, v75
  v_fma_f32 v72, v8, v74, v84
  v_fma_f32 v73, v8, v75, v100
  v_fma_f32 v72, -v9, v75, v72
  v_fma_f32 v73, v9, v74, v73
  v_fma_f32 v74, v8, v72, v85
  v_fma_f32 v75, v8, v73, v101
  v_fma_f32 v74, -v9, v73, v74
  v_fma_f32 v75, v9, v72, v75
  v_fma_f32 v72, v8, v74, v86
  v_fma_f32 v73, v8, v75, v102
  v_fma_f32 v72, -v9, v75, v72
  v_fma_f32 v73, v9, v74, v73
  v_fma_f32 v74, v8, v72, v87
  v_fma_f32 v75, v8, v73, v103
  v_fma_f32 v74, -v9, v73, v74
  v_fma_f32 v75, v9, v72, v75
  v_fma_f32 v72, v8, v74, v88
  v_fma_f32 v73, v8, v75, v104
  v_fma_f32 v72, -v9, v75, v72
  v_fma_f32 v73, v9, v74, v73
  v_fma_f32 v74, v8, v72, v89
  v_fma_f32 v75, v8, v73, v105
  v_fma_f32 v74, -v9, v73, v74
  v_fma_f32 v75, v9, v72, v75
  v_fma_f32 v72, v8, v74, v90
  v_fma_f32 v73, v8, v75, v106
  v_fma_f32 v72, -v9, v75, v72
  v_fma_f32 v73, v9, v74, v73
  v_fma_f32 v74, v8, v72, v91
  v_fma_f32 v75, v8, v73, v107
  v_fma_f32 v74, -v9, v73, v74
  v_fma_f32 v75, v9, v72, v75
  v_fma_f32 v72, v8, v74, v92
  v_fma_f32 v73, v8, v75, v108
  v_fma_f32 v72, -v9, v75, v72
  v_fma_f32 v73, v9, v74, v73
  v_fma_f32 v74, v8, v72, v93
  v_fma_f32 v75, v8, v73, v109
  v_fma_f32 v74, -v9, v73, v74
  v_fma_f32 v75, v9, v72, v75
  v_fma_f32 v72, v8, v74, v94
  v_fma_f32 v73, v8, v75, v110
  v_fma_f32 v72, -v9, v75, v72
  v_fma_f32 v73, v9, v74, v73
  v_fma_f32 v74, v8, v72, v95
  v_fma_f32 v75, v8, v73, v111
  v_fma_f32 v74, -v9, v73, v74
  v_fma_f32 v75, v9, v72, v75
  v_mov_b32 v76, v74
  v_mov_b32 v78, v74
  v_mov_b32 v77, v75
  v_mov_b32 v79, v75
  s_lshl_b32 s54, s52, 8
  s_add_u32 s54, s54, 160768
  v_permlane32_swap_b32 v76, v78
  v_permlane32_swap_b32 v77, v79
  v_lshlrev_b32 v5, 3, v1
  v_add_u32 v6, s54, v5
  v_pk_fma_f32 v[112:113], v[12:13], v[76:77], v[78:79] op_sel:[0,0,0] op_sel_hi:[0,1,1]
  v_pk_fma_f32 v[112:113], v[12:13], v[76:77], v[112:113] op_sel:[1,1,0] op_sel_hi:[1,0,1] neg_lo:[1,0,0]
  s_lshl_b32 s53, s4, 1
  s_add_u32 s53, s53, s51
  s_lshl_b32 s56, s52, 2
  s_add_u32 s56, s56, 163168
  v_mov_b32 v3, s56
  s_cmp_eq_u32 s51, 0
  s_cbranch_scc0 L_e1
  v_mov_b32 v4, 1
  ds_write_b64 v6, v[112:113]
  ds_write_b32 v3, v4
  s_cmp_eq_u32 s52, 0
  s_cbranch_scc0 L_e2
  s_lshl_b32 s48, s5, 14
  s_add_u32 s48, s48, 524288
  s_add_u32 s50, s4, 8
  s_lshl_b32 s50, s50, 2
  v_add_u32 v3, s50, v0
  v_and_b32 v3, 127, v3
  v_lshlrev_b32 v3, 7, v3
  s_mov_b32 s49, 0
Lkvp25:
  buffer_load_dword v4, v3, s[16:19], s48 offen sc0 sc1
  s_add_u32 s49, s49, 1
  s_waitcnt vmcnt(0)
  v_cmp_ne_u32 vcc, s6, v4
  s_cmp_gt_u32 s49, 200000
  s_cbranch_scc1 Lkvpgo26
  s_cbranch_vccz Lkvpgo26
  s_sleep 2
  s_branch Lkvp25
Lkvpgo26:
  s_mov_b64 exec, -1
  s_lshl_b32 s48, s5, 14
  s_add_u32 s48, s48, 524288
  s_add_u32 s50, s4, 24
  s_lshl_b32 s50, s50, 2
  v_add_u32 v3, s50, v0
  v_and_b32 v3, 127, v3
  v_lshlrev_b32 v3, 7, v3
  s_mov_b32 s49, 0
  s_mov_b32 exec_hi, 0
Lkvp27:
  buffer_load_dword v4, v3, s[16:19], s48 offen sc0 sc1
  s_add_u32 s49, s49, 1
  s_waitcnt vmcnt(0)
  v_cmp_ne_u32 vcc, s6, v4
  s_cmp_gt_u32 s49, 200000
  s_cbranch_scc1 Lkvpgo28
  s_cbranch_vccz Lkvpgo28
  s_sleep 2
  s_branch Lkvp27
Lkvpgo28:
  s_mov_b64 exec, -1
  v_mov_b32 v3, 163092
  v_mov_b32 v4, 1
  s_mov_b64 exec, 1
  ds_add_u32 v3, v4
  s_mov_b64 exec, -1
  s_branch L_e2
L_e1:
  s_mov_b32 s49, 0
Lpg29:
  ds_read_b32 v4, v3
  ds_read_b64 v[114:115], v6
  s_add_u32 s49, s49, 1
  s_waitcnt lgkmcnt(0)
  v_readfirstlane_b32 s50, v4
  s_cmp_gt_u32 s49, 1600000
  s_cbranch_scc1 Lpggo30
  s_cmp_eq_u32 s50, 0
  s_cbranch_scc1 Lpg29
Lpggo30:
  v_pk_fma_f32 v[72:73], v[14:15], v[114:115], v[112:113] op_sel:[0,0,0] op_sel_hi:[0,1,1]
  v_pk_fma_f32 v[72:73], v[14:15], v[114:115], v[72:73] op_sel:[1,1,0] op_sel_hi:[1,0,1] neg_lo:[1,0,0]
  s_lshl_b32 s54, s4, 8
  s_mov_b32 exec_hi, 0
  buffer_store_dwordx2 v[72:73], v5, s[44:47], s54 offen sc1
  s_mov_b64 exec, -1
  s_waitcnt vmcnt(0)
  v_mov_b32 v3, 163072
  v_mov_b32 v4, 1
  s_mov_b64 exec, 1
  ds_add_rtn_u32 v4, v3, v4
  s_waitcnt lgkmcnt(0)
  s_mov_b64 exec, -1
  v_readfirstlane_b32 s49, v4
  s_cmp_eq_u32 s49, 1
  s_cbranch_scc0 Larr31
  s_lshl_b32 s48, s4, 3
  s_add_u32 s48, s48, s5
  s_lshl_b32 s48, s48, 7
  s_add_u32 s48, s48, 36864
  v_mov_b32 v3, s48
  v_mov_b32 v4, s6
  s_mov_b64 exec, 1
  buffer_store_dword v4, v3, s[16:19], 0 offen sc1
  s_mov_b64 exec, -1
Larr31:
L_e2:
  s_lshl_b32 s70, s5, 16
  s_lshl_b32 s71, s52, 15
  s_lshl_b32 s58, s51, 12
  s_add_u32 s71, s71, s58
  v_mov_b32 v3, 163084
  s_mov_b32 s49, 0
Llw32:
  ds_read_b32 v4, v3
  s_add_u32 s49, s49, 1
  s_waitcnt lgkmcnt(0)
  v_readfirstlane_b32 s50, v4
  s_cmp_gt_u32 s49, 1600000
  s_cbranch_scc1 Llwgo33
  s_cmp_ge_u32 s50, 4
  s_cbranch_scc1 Llwgo33
  s_sleep 1
  s_branch Llw32
Llwgo33:
  s_setprio 0
  s_add_u32 s59, s4, 0
  s_and_b32 s59, s59, 7
  s_and_b32 s60, s59, 4
  s_lshl_b32 s60, s60, 14
  s_add_u32 s60, s60, s71
  s_and_b32 s58, s59, 3
  s_lshl_b32 s58, s58, 13
  s_add_u32 s60, s60, s58
  s_lshl_b32 s59, s59, 7
  s_add_u32 s59, s59, s70
  s_add_u32 m0, s60, 0
  s_add_u32 s58, s59, 0
  buffer_load_dwordx4 v162, s[32:35], s58 offen lds
  s_waitcnt vmcnt(3)
  s_add_u32 m0, s60, 1024
  s_add_u32 s58, s59, 0
  buffer_load_dwordx4 v163, s[32:35], s58 offen lds
  s_waitcnt vmcnt(3)
  s_add_u32 m0, s60, 2048
  s_add_u32 s58, s59, 16384
  buffer_load_dwordx4 v162, s[32:35], s58 offen lds
  s_waitcnt vmcnt(3)
  s_add_u32 m0, s60, 3072
  s_add_u32 s58, s59, 16384
  buffer_load_dwordx4 v163, s[32:35], s58 offen lds
  s_waitcnt vmcnt(3)
  s_add_u32 s59, s4, 1
  s_and_b32 s59, s59, 7
  s_and_b32 s60, s59, 4
  s_lshl_b32 s60, s60, 14
  s_add_u32 s60, s60, s71
  s_and_b32 s58, s59, 3
  s_lshl_b32 s58, s58, 13
  s_add_u32 s60, s60, s58
  s_lshl_b32 s59, s59, 7
  s_add_u32 s59, s59, s70
  s_add_u32 m0, s60, 0
  s_add_u32 s58, s59, 0
  buffer_load_dwordx4 v162, s[32:35], s58 offen lds
  s_waitcnt vmcnt(3)
  s_add_u32 m0, s60, 1024
  s_add_u32 s58, s59, 0
  buffer_load_dwordx4 v163, s[32:35], s58 offen lds
  s_waitcnt vmcnt(3)
  s_add_u32 m0, s60, 2048
  s_add_u32 s58, s59, 16384
  buffer_load_dwordx4 v162, s[32:35], s58 offen lds
  s_waitcnt vmcnt(3)
  s_add_u32 m0, s60, 3072
  s_add_u32 s58, s59, 16384
  buffer_load_dwordx4 v163, s[32:35], s58 offen lds
  s_waitcnt vmcnt(3)
  s_add_u32 s59, s4, 2
  s_and_b32 s59, s59, 7
  s_and_b32 s60, s59, 4
  s_lshl_b32 s60, s60, 14
  s_add_u32 s60, s60, s71
  s_and_b32 s58, s59, 3
  s_lshl_b32 s58, s58, 13
  s_add_u32 s60, s60, s58
  s_lshl_b32 s59, s59, 7
  s_add_u32 s59, s59, s70
  s_add_u32 m0, s60, 0
  s_add_u32 s58, s59, 0
  buffer_load_dwordx4 v162, s[32:35], s58 offen lds
  s_waitcnt vmcnt(3)
  s_add_u32 m0, s60, 1024
  s_add_u32 s58, s59, 0
  buffer_load_dwordx4 v163, s[32:35], s58 offen lds
  s_waitcnt vmcnt(3)
  s_add_u32 m0, s60, 2048
  s_add_u32 s58, s59, 16384
  buffer_load_dwordx4 v162, s[32:35], s58 offen lds
  s_waitcnt vmcnt(3)
  s_add_u32 m0, s60, 3072
  s_add_u32 s58, s59, 16384
  buffer_load_dwordx4 v163, s[32:35], s58 offen lds
  s_waitcnt vmcnt(3)
  s_setprio 3
  s_cmp_eq_u32 s4, 0
  s_cbranch_scc1 L_noe
  s_lshl_b32 s48, s5, 7
  v_lshlrev_b32 v3, 10, v0
  s_add_u32 s48, s48, 36864
  v_add_u32 v3, s48, v3
  v_cmp_gt_u32 vcc, s4, v0
  s_mov_b32 s49, 0
  s_mov_b64 exec, vcc
Lpoll34:
  buffer_load_dword v4, v3, s[16:19], 0 offen sc0 sc1
  s_add_u32 s49, s49, 1
  s_waitcnt vmcnt(0)
  v_cmp_ne_u32 vcc, s6, v4
  s_cmp_gt_u32 s49, 200000
  s_cbranch_scc1 Lpollgo35
  s_cbranch_vccz Lpollgo35
  s_sleep 10
  s_branch Lpoll34
Lpollgo35:
  s_mov_b64 exec, -1
L_noe:
  s_sub_u32 s54, s4, 31
  s_lshl_b32 s54, s54, 8
  v_lshlrev_b32 v6, 8, v2
  v_sub_u32 v6, v5, v6
  v_add_u32 v6, s54, v6
  buffer_load_dwordx2 v[128:129], v6, s[44:47], 0 offen sc1
  v_add_u32 v6, 512, v6
  buffer_load_dwordx2 v[130:131], v6, s[44:47], 0 offen sc1
  v_add_u32 v6, 512, v6
  buffer_load_dwordx2 v[132:133], v6, s[44:47], 0 offen sc1
  v_add_u32 v6, 512, v6
  buffer_load_dwordx2 v[134:135], v6, s[44:47], 0 offen sc1
  v_add_u32 v6, 512, v6
  buffer_load_dwordx2 v[136:137], v6, s[44:47], 0 offen sc1
  v_add_u32 v6, 512, v6
  buffer_load_dwordx2 v[138:139], v6, s[44:47], 0 offen sc1
  v_add_u32 v6, 512, v6
  buffer_load_dwordx2 v[140:141], v6, s[44:47], 0 offen sc1
  v_add_u32 v6, 512, v6
  buffer_load_dwordx2 v[142:143], v6, s[44:47], 0 offen sc1
  v_add_u32 v6, 512, v6
  v_mov_b32 v72, 0
  v_mov_b32 v73, 0
  s_waitcnt vmcnt(7)
  v_pk_fma_f32 v[74:75], v[18:19], v[72:73], v[128:129] op_sel:[0,0,0] op_sel_hi:[0,1,1]
  v_pk_fma_f32 v[72:73], v[18:19], v[72:73], v[74:75] op_sel:[1,1,0] op_sel_hi:[1,0,1] neg_lo:[1,0,0]
  buffer_load_dwordx2 v[128:129], v6, s[44:47], 0 offen sc1
  v_add_u32 v6, 512, v6
  s_waitcnt vmcnt(7)
  v_pk_fma_f32 v[74:75], v[18:19], v[72:73], v[130:131] op_sel:[0,0,0] op_sel_hi:[0,1,1]
  v_pk_fma_f32 v[72:73], v[18:19], v[72:73], v[74:75] op_sel:[1,1,0] op_sel_hi:[1,0,1] neg_lo:[1,0,0]
  buffer_load_dwordx2 v[130:131], v6, s[44:47], 0 offen sc1
  v_add_u32 v6, 512, v6
  s_waitcnt vmcnt(7)
  v_pk_fma_f32 v[74:75], v[18:19], v[72:73], v[132:133] op_sel:[0,0,0] op_sel_hi:[0,1,1]
  v_pk_fma_f32 v[72:73], v[18:19], v[72:73], v[74:75] op_sel:[1,1,0] op_sel_hi:[1,0,1] neg_lo:[1,0,0]
  buffer_load_dwordx2 v[132:133], v6, s[44:47], 0 offen sc1
  v_add_u32 v6, 512, v6
  s_waitcnt vmcnt(7)
  v_pk_fma_f32 v[74:75], v[18:19], v[72:73], v[134:135] op_sel:[0,0,0] op_sel_hi:[0,1,1]
  v_pk_fma_f32 v[72:73], v[18:19], v[72:73], v[74:75] op_sel:[1,1,0] op_sel_hi:[1,0,1] neg_lo:[1,0,0]
  buffer_load_dwordx2 v[134:135], v6, s[44:47], 0 offen sc1
  v_add_u32 v6, 512, v6
  s_waitcnt vmcnt(7)
  v_pk_fma_f32 v[74:75], v[18:19], v[72:73], v[136:137] op_sel:[0,0,0] op_sel_hi:[0,1,1]
  v_pk_fma_f32 v[72:73], v[18:19], v[72:73], v[74:75] op_sel:[1,1,0] op_sel_hi:[1,0,1] neg_lo:[1,0,0]
  buffer_load_dwordx2 v[136:137], v6, s[44:47], 0 offen sc1
  v_add_u32 v6, 512, v6
  s_waitcnt vmcnt(7)
  v_pk_fma_f32 v[74:75], v[18:19], v[72:73], v[138:139] op_sel:[0,0,0] op_sel_hi:[0,1,1]
  v_pk_fma_f32 v[72:73], v[18:19], v[72:73], v[74:75] op_sel:[1,1,0] op_sel_hi:[1,0,1] neg_lo:[1,0,0]
  buffer_load_dwordx2 v[138:139], v6, s[44:47], 0 offen sc1
  v_add_u32 v6, 512, v6
  s_waitcnt vmcnt(7)
  v_pk_fma_f32 v[74:75], v[18:19], v[72:73], v[140:141] op_sel:[0,0,0] op_sel_hi:[0,1,1]
  v_pk_fma_f32 v[72:73], v[18:19], v[72:73], v[74:75] op_sel:[1,1,0] op_sel_hi:[1,0,1] neg_lo:[1,0,0]
  buffer_load_dwordx2 v[140:141], v6, s[44:47], 0 offen sc1
  v_add_u32 v6, 512, v6
  s_waitcnt vmcnt(7)
  v_pk_fma_f32 v[74:75], v[18:19], v[72:73], v[142:143] op_sel:[0,0,0] op_sel_hi:[0,1,1]
  v_pk_fma_f32 v[72:73], v[18:19], v[72:73], v[74:75] op_sel:[1,1,0] op_sel_hi:[1,0,1] neg_lo:[1,0,0]
  buffer_load_dwordx2 v[142:143], v6, s[44:47], 0 offen sc1
  s_waitcnt vmcnt(7)
  v_pk_fma_f32 v[74:75], v[18:19], v[72:73], v[128:129] op_sel:[0,0,0] op_sel_hi:[0,1,1]
  v_pk_fma_f32 v[72:73], v[18:19], v[72:73], v[74:75] op_sel:[1,1,0] op_sel_hi:[1,0,1] neg_lo:[1,0,0]
  s_waitcnt vmcnt(6)
  v_pk_fma_f32 v[74:75], v[18:19], v[72:73], v[130:131] op_sel:[0,0,0] op_sel_hi:[0,1,1]
  v_pk_fma_f32 v[72:73], v[18:19], v[72:73], v[74:75] op_sel:[1,1,0] op_sel_hi:[1,0,1] neg_lo:[1,0,0]
  s_waitcnt vmcnt(5)
  v_pk_fma_f32 v[74:75], v[18:19], v[72:73], v[132:133] op_sel:[0,0,0] op_sel_hi:[0,1,1]
  v_pk_fma_f32 v[72:73], v[18:19], v[72:73], v[74:75] op_sel:[1,1,0] op_sel_hi:[1,0,1] neg_lo:[1,0,0]
  s_waitcnt vmcnt(4)
  v_pk_fma_f32 v[74:75], v[18:19], v[72:73], v[134:135] op_sel:[0,0,0] op_sel_hi:[0,1,1]
  v_pk_fma_f32 v[72:73], v[18:19], v[72:73], v[74:75] op_sel:[1,1,0] op_sel_hi:[1,0,1] neg_lo:[1,0,0]
  s_waitcnt vmcnt(3)
  v_pk_fma_f32 v[74:75], v[18:19], v[72:73], v[136:137] op_sel:[0,0,0] op_sel_hi:[0,1,1]
  v_pk_fma_f32 v[72:73], v[18:19], v[72:73], v[74:75] op_sel:[1,1,0] op_sel_hi:[1,0,1] neg_lo:[1,0,0]
  s_waitcnt vmcnt(2)
  v_pk_fma_f32 v[74:75], v[18:19], v[72:73], v[138:139] op_sel:[0,0,0] op_sel_hi:[0,1,1]
  v_pk_fma_f32 v[72:73], v[18:19], v[72:73], v[74:75] op_sel:[1,1,0] op_sel_hi:[1,0,1] neg_lo:[1,0,0]
  s_waitcnt vmcnt(1)
  v_pk_fma_f32 v[74:75], v[18:19], v[72:73], v[140:141] op_sel:[0,0,0] op_sel_hi:[0,1,1]
  v_pk_fma_f32 v[72:73], v[18:19], v[72:73], v[74:75] op_sel:[1,1,0] op_sel_hi:[1,0,1] neg_lo:[1,0,0]
  s_waitcnt vmcnt(0)
  v_pk_fma_f32 v[74:75], v[18:19], v[72:73], v[142:143] op_sel:[0,0,0] op_sel_hi:[0,1,1]
  v_pk_fma_f32 v[72:73], v[18:19], v[72:73], v[74:75] op_sel:[1,1,0] op_sel_hi:[1,0,1] neg_lo:[1,0,0]
  v_mov_b32 v116, v72
  v_mov_b32 v118, v72
  v_mov_b32 v117, v73
  v_mov_b32 v119, v73
  s_nop 1
  v_permlane32_swap_b32 v116, v118
  v_permlane32_swap_b32 v117, v119
  v_pk_fma_f32 v[120:121], v[16:17], v[118:119], v[116:117] op_sel:[0,0,0] op_sel_hi:[0,1,1]
  v_pk_fma_f32 v[120:121], v[16:17], v[118:119], v[120:121] op_sel:[1,1,0] op_sel_hi:[1,0,1] neg_lo:[1,0,0]
  s_cmp_eq_u32 s51, 0
  s_cbranch_scc1 L_h0
  v_pk_fma_f32 v[122:123], v[14:15], v[120:121], v[114:115] op_sel:[0,0,0] op_sel_hi:[0,1,1]
  v_pk_fma_f32 v[122:123], v[14:15], v[120:121], v[122:123] op_sel:[1,1,0] op_sel_hi:[1,0,1] neg_lo:[1,0,0]
  v_mov_b32 v120, v122
  v_mov_b32 v121, v123
L_h0:
  v_pk_fma_f32 v[122:123], v[12:13], v[120:121], v[76:77] op_sel:[0,0,0] op_sel_hi:[0,1,1]
  v_pk_fma_f32 v[122:123], v[12:13], v[120:121], v[122:123] op_sel:[1,1,0] op_sel_hi:[1,0,1] neg_lo:[1,0,0]
  s_mov_b32 exec_lo, 0
  v_mov_b32 v120, v122
  v_mov_b32 v121, v123
  s_mov_b32 exec_lo, -1
  v_fmac_f32 v80, v8, v120
  v_fmac_f32 v96, v8, v121
  v_fma_f32 v80, -v9, v121, v80
  v_fmac_f32 v96, v9, v120
  v_fmac_f32 v81, v8, v80
  v_fmac_f32 v97, v8, v96
  v_fma_f32 v81, -v9, v96, v81
  v_fmac_f32 v97, v9, v80
  v_fmac_f32 v82, v8, v81
  v_fmac_f32 v98, v8, v97
  v_fma_f32 v82, -v9, v97, v82
  v_fmac_f32 v98, v9, v81
  v_fmac_f32 v83, v8, v82
  v_fmac_f32 v99, v8, v98
  v_fma_f32 v83, -v9, v98, v83
  v_fmac_f32 v99, v9, v82
  v_fmac_f32 v84, v8, v83
  v_fmac_f32 v100, v8, v99
  v_fma_f32 v84, -v9, v99, v84
  v_fmac_f32 v100, v9, v83
  v_fmac_f32 v85, v8, v84
  v_fmac_f32 v101, v8, v100
  v_fma_f32 v85, -v9, v100, v85
  v_fmac_f32 v101, v9, v84
  v_fmac_f32 v86, v8, v85
  v_fmac_f32 v102, v8, v101
  v_fma_f32 v86, -v9, v101, v86
  v_fmac_f32 v102, v9, v85
  v_fmac_f32 v87, v8, v86
  v_fmac_f32 v103, v8, v102
  v_fma_f32 v87, -v9, v102, v87
  v_fmac_f32 v103, v9, v86
  v_fmac_f32 v88, v8, v87
  v_fmac_f32 v104, v8, v103
  v_fma_f32 v88, -v9, v103, v88
  v_fmac_f32 v104, v9, v87
  v_fmac_f32 v89, v8, v88
  v_fmac_f32 v105, v8, v104
  v_fma_f32 v89, -v9, v104, v89
  v_fmac_f32 v105, v9, v88
  v_fmac_f32 v90, v8, v89
  v_fmac_f32 v106, v8, v105
  v_fma_f32 v90, -v9, v105, v90
  v_fmac_f32 v106, v9, v89
  v_fmac_f32 v91, v8, v90
  v_fmac_f32 v107, v8, v106
  v_fma_f32 v91, -v9, v106, v91
  v_fmac_f32 v107, v9, v90
  v_fmac_f32 v92, v8, v91
  v_fmac_f32 v108, v8, v107
  v_fma_f32 v92, -v9, v107, v92
  v_fmac_f32 v108, v9, v91
  v_fmac_f32 v93, v8, v92
  v_fmac_f32 v109, v8, v108
  v_fma_f32 v93, -v9, v108, v93
  v_fmac_f32 v109, v9, v92
  v_fmac_f32 v94, v8, v93
  v_fmac_f32 v110, v8, v109
  v_fma_f32 v94, -v9, v109, v94
  v_fmac_f32 v110, v9, v93
  v_fmac_f32 v95, v8, v94
  v_fmac_f32 v111, v8, v110
  v_fma_f32 v95, -v9, v110, v95
  v_fmac_f32 v111, v9, v94
  v_pk_mul_f32 v[72:73], v[80:81], v[10:11] op_sel:[0,0] op_sel_hi:[1,0]
  v_pk_mul_f32 v[74:75], v[80:81], v[10:11] op_sel:[0,1] op_sel_hi:[1,1]
  v_pk_fma_f32 v[72:73], v[96:97], v[10:11], v[72:73] op_sel:[0,1,0] op_sel_hi:[1,1,1] neg_lo:[1,0,0] neg_hi:[1,0,0]
  v_pk_fma_f32 v[74:75], v[96:97], v[10:11], v[74:75] op_sel:[0,0,0] op_sel_hi:[1,0,1] neg_lo:[1,0,1] neg_hi:[1,0,1]
  v_pk_mul_f32 v[72:73], v[72:73], v[48:49]
  v_pk_mul_f32 v[74:75], v[74:75], v[48:49]
  v_cvt_pk_bf16_f32 v128, v72, v73
  v_cvt_pk_bf16_f32 v136, v74, v75
  v_pk_mul_f32 v[72:73], v[82:83], v[10:11] op_sel:[0,0] op_sel_hi:[1,0]
  v_pk_mul_f32 v[74:75], v[82:83], v[10:11] op_sel:[0,1] op_sel_hi:[1,1]
  v_pk_fma_f32 v[72:73], v[98:99], v[10:11], v[72:73] op_sel:[0,1,0] op_sel_hi:[1,1,1] neg_lo:[1,0,0] neg_hi:[1,0,0]
  v_pk_fma_f32 v[74:75], v[98:99], v[10:11], v[74:75] op_sel:[0,0,0] op_sel_hi:[1,0,1] neg_lo:[1,0,1] neg_hi:[1,0,1]
  v_pk_mul_f32 v[72:73], v[72:73], v[50:51]
  v_pk_mul_f32 v[74:75], v[74:75], v[50:51]
  v_cvt_pk_bf16_f32 v129, v72, v73
  v_cvt_pk_bf16_f32 v137, v74, v75
  v_pk_mul_f32 v[72:73], v[84:85], v[10:11] op_sel:[0,0] op_sel_hi:[1,0]
  v_pk_mul_f32 v[74:75], v[84:85], v[10:11] op_sel:[0,1] op_sel_hi:[1,1]
  v_pk_fma_f32 v[72:73], v[100:101], v[10:11], v[72:73] op_sel:[0,1,0] op_sel_hi:[1,1,1] neg_lo:[1,0,0] neg_hi:[1,0,0]
  v_pk_fma_f32 v[74:75], v[100:101], v[10:11], v[74:75] op_sel:[0,0,0] op_sel_hi:[1,0,1] neg_lo:[1,0,1] neg_hi:[1,0,1]
  v_pk_mul_f32 v[72:73], v[72:73], v[52:53]
  v_pk_mul_f32 v[74:75], v[74:75], v[52:53]
  v_cvt_pk_bf16_f32 v130, v72, v73
  v_cvt_pk_bf16_f32 v138, v74, v75
  v_pk_mul_f32 v[72:73], v[86:87], v[10:11] op_sel:[0,0] op_sel_hi:[1,0]
  v_pk_mul_f32 v[74:75], v[86:87], v[10:11] op_sel:[0,1] op_sel_hi:[1,1]
  v_pk_fma_f32 v[72:73], v[102:103], v[10:11], v[72:73] op_sel:[0,1,0] op_sel_hi:[1,1,1] neg_lo:[1,0,0] neg_hi:[1,0,0]
  v_pk_fma_f32 v[74:75], v[102:103], v[10:11], v[74:75] op_sel:[0,0,0] op_sel_hi:[1,0,1] neg_lo:[1,0,1] neg_hi:[1,0,1]
  v_pk_mul_f32 v[72:73], v[72:73], v[54:55]
  v_pk_mul_f32 v[74:75], v[74:75], v[54:55]
  v_cvt_pk_bf16_f32 v131, v72, v73
  v_cvt_pk_bf16_f32 v139, v74, v75
  v_pk_mul_f32 v[72:73], v[88:89], v[10:11] op_sel:[0,0] op_sel_hi:[1,0]
  v_pk_mul_f32 v[74:75], v[88:89], v[10:11] op_sel:[0,1] op_sel_hi:[1,1]
  v_pk_fma_f32 v[72:73], v[104:105], v[10:11], v[72:73] op_sel:[0,1,0] op_sel_hi:[1,1,1] neg_lo:[1,0,0] neg_hi:[1,0,0]
  v_pk_fma_f32 v[74:75], v[104:105], v[10:11], v[74:75] op_sel:[0,0,0] op_sel_hi:[1,0,1] neg_lo:[1,0,1] neg_hi:[1,0,1]
  v_pk_mul_f32 v[72:73], v[72:73], v[56:57]
  v_pk_mul_f32 v[74:75], v[74:75], v[56:57]
  v_cvt_pk_bf16_f32 v132, v72, v73
  v_cvt_pk_bf16_f32 v140, v74, v75
  v_pk_mul_f32 v[72:73], v[90:91], v[10:11] op_sel:[0,0] op_sel_hi:[1,0]
  v_pk_mul_f32 v[74:75], v[90:91], v[10:11] op_sel:[0,1] op_sel_hi:[1,1]
  v_pk_fma_f32 v[72:73], v[106:107], v[10:11], v[72:73] op_sel:[0,1,0] op_sel_hi:[1,1,1] neg_lo:[1,0,0] neg_hi:[1,0,0]
  v_pk_fma_f32 v[74:75], v[106:107], v[10:11], v[74:75] op_sel:[0,0,0] op_sel_hi:[1,0,1] neg_lo:[1,0,1] neg_hi:[1,0,1]
  v_pk_mul_f32 v[72:73], v[72:73], v[58:59]
  v_pk_mul_f32 v[74:75], v[74:75], v[58:59]
  v_cvt_pk_bf16_f32 v133, v72, v73
  v_cvt_pk_bf16_f32 v141, v74, v75
  v_pk_mul_f32 v[72:73], v[92:93], v[10:11] op_sel:[0,0] op_sel_hi:[1,0]
  v_pk_mul_f32 v[74:75], v[92:93], v[10:11] op_sel:[0,1] op_sel_hi:[1,1]
  v_pk_fma_f32 v[72:73], v[108:109], v[10:11], v[72:73] op_sel:[0,1,0] op_sel_hi:[1,1,1] neg_lo:[1,0,0] neg_hi:[1,0,0]
  v_pk_fma_f32 v[74:75], v[108:109], v[10:11], v[74:75] op_sel:[0,0,0] op_sel_hi:[1,0,1] neg_lo:[1,0,1] neg_hi:[1,0,1]
  v_pk_mul_f32 v[72:73], v[72:73], v[60:61]
  v_pk_mul_f32 v[74:75], v[74:75], v[60:61]
  v_cvt_pk_bf16_f32 v134, v72, v73
  v_cvt_pk_bf16_f32 v142, v74, v75
  v_pk_mul_f32 v[72:73], v[94:95], v[10:11] op_sel:[0,0] op_sel_hi:[1,0]
  v_pk_mul_f32 v[74:75], v[94:95], v[10:11] op_sel:[0,1] op_sel_hi:[1,1]
  v_pk_fma_f32 v[72:73], v[110:111], v[10:11], v[72:73] op_sel:[0,1,0] op_sel_hi:[1,1,1] neg_lo:[1,0,0] neg_hi:[1,0,0]
  v_pk_fma_f32 v[74:75], v[110:111], v[10:11], v[74:75] op_sel:[0,0,0] op_sel_hi:[1,0,1] neg_lo:[1,0,1] neg_hi:[1,0,1]
  v_pk_mul_f32 v[72:73], v[72:73], v[62:63]
  v_pk_mul_f32 v[74:75], v[74:75], v[62:63]
  v_cvt_pk_bf16_f32 v135, v72, v73
  v_cvt_pk_bf16_f32 v143, v74, v75
  s_nop 1
  v_mfma_f32_32x32x16_bf16 v[80:95], v[128:131], v[64:67], 0
  v_mfma_f32_32x32x16_bf16 v[80:95], v[132:135], v[68:71], v[80:95]
  v_mfma_f32_32x32x16_bf16 v[96:111], v[136:139], v[64:67], 0
  v_mfma_f32_32x32x16_bf16 v[96:111], v[140:143], v[68:71], v[96:111]
  s_lshl_b32 s54, s53, 6
  s_lshl_b32 s56, s5, 2
  s_add_u32 s54, s54, s56
  s_lshl_b32 s56, s52, 1
  s_add_u32 s54, s54, s56
  s_lshl_b32 s54, s54, 10
  s_add_u32 s54, s54, 5242880
  s_add_u32 s56, s54, 32768
  v_lshlrev_b32 v5, 4, v0
  s_nop 2
  v_cvt_pk_bf16_f32 v128, v80, v81
  v_cvt_pk_bf16_f32 v129, v82, v83
  v_cvt_pk_bf16_f32 v130, v84, v85
  v_cvt_pk_bf16_f32 v131, v86, v87
  buffer_store_dwordx4 v[128:131], v5, s[16:19], s54 offen offset:0 sc1
  v_cvt_pk_bf16_f32 v132, v88, v89
  v_cvt_pk_bf16_f32 v133, v90, v91
  v_cvt_pk_bf16_f32 v134, v92, v93
  v_cvt_pk_bf16_f32 v135, v94, v95
  buffer_store_dwordx4 v[132:135], v5, s[16:19], s54 offen offset:1024 sc1
  v_cvt_pk_bf16_f32 v136, v96, v97
  v_cvt_pk_bf16_f32 v137, v98, v99
  v_cvt_pk_bf16_f32 v138, v100, v101
  v_cvt_pk_bf16_f32 v139, v102, v103
  buffer_store_dwordx4 v[136:139], v5, s[16:19], s56 offen offset:0 sc1
  v_cvt_pk_bf16_f32 v140, v104, v105
  v_cvt_pk_bf16_f32 v141, v106, v107
  v_cvt_pk_bf16_f32 v142, v108, v109
  v_cvt_pk_bf16_f32 v143, v110, v111
  buffer_store_dwordx4 v[140:143], v5, s[16:19], s56 offen offset:1024 sc1
  s_waitcnt vmcnt(0)
  v_mov_b32 v3, 163076
  v_mov_b32 v4, 1
  s_mov_b64 exec, 1
  ds_add_rtn_u32 v4, v3, v4
  s_waitcnt lgkmcnt(0)
  s_mov_b64 exec, -1
  v_readfirstlane_b32 s49, v4
  s_cmp_eq_u32 s49, 3
  s_cbranch_scc0 Larr36
  s_lshl_b32 s48, s4, 3
  s_add_u32 s48, s48, s5
  s_lshl_b32 s48, s48, 7
  s_add_u32 s48, s48, 69632
  v_mov_b32 v3, s48
  v_mov_b32 v4, s6
  s_mov_b64 exec, 1
  buffer_store_dword v4, v3, s[16:19], 0 offen sc1
  s_mov_b64 exec, -1
Larr36:
  s_setprio 0
  s_add_u32 s59, s4, 3
  s_and_b32 s59, s59, 7
  s_and_b32 s60, s59, 4
  s_lshl_b32 s60, s60, 14
  s_add_u32 s60, s60, s71
  s_and_b32 s58, s59, 3
  s_lshl_b32 s58, s58, 13
  s_add_u32 s60, s60, s58
  s_lshl_b32 s59, s59, 7
  s_add_u32 s59, s59, s70
  s_add_u32 m0, s60, 0
  s_add_u32 s58, s59, 0
  buffer_load_dwordx4 v162, s[32:35], s58 offen lds
  s_waitcnt vmcnt(3)
  s_add_u32 m0, s60, 1024
  s_add_u32 s58, s59, 0
  buffer_load_dwordx4 v163, s[32:35], s58 offen lds
  s_waitcnt vmcnt(3)
  s_add_u32 m0, s60, 2048
  s_add_u32 s58, s59, 16384
  buffer_load_dwordx4 v162, s[32:35], s58 offen lds
  s_waitcnt vmcnt(3)
  s_add_u32 m0, s60, 3072
  s_add_u32 s58, s59, 16384
  buffer_load_dwordx4 v163, s[32:35], s58 offen lds
  s_waitcnt vmcnt(3)
  s_add_u32 s59, s4, 4
  s_and_b32 s59, s59, 7
  s_and_b32 s60, s59, 4
  s_lshl_b32 s60, s60, 14
  s_add_u32 s60, s60, s71
  s_and_b32 s58, s59, 3
  s_lshl_b32 s58, s58, 13
  s_add_u32 s60, s60, s58
  s_lshl_b32 s59, s59, 7
  s_add_u32 s59, s59, s70
  s_add_u32 m0, s60, 0
  s_add_u32 s58, s59, 0
  buffer_load_dwordx4 v162, s[32:35], s58 offen lds
  s_waitcnt vmcnt(3)
  s_add_u32 m0, s60, 1024
  s_add_u32 s58, s59, 0
  buffer_load_dwordx4 v163, s[32:35], s58 offen lds
  s_waitcnt vmcnt(3)
  s_add_u32 m0, s60, 2048
  s_add_u32 s58, s59, 16384
  buffer_load_dwordx4 v162, s[32:35], s58 offen lds
  s_waitcnt vmcnt(3)
  s_add_u32 m0, s60, 3072
  s_add_u32 s58, s59, 16384
  buffer_load_dwordx4 v163, s[32:35], s58 offen lds
  s_waitcnt vmcnt(3)
  s_add_u32 s59, s4, 5
  s_and_b32 s59, s59, 7
  s_and_b32 s60, s59, 4
  s_lshl_b32 s60, s60, 14
  s_add_u32 s60, s60, s71
  s_and_b32 s58, s59, 3
  s_lshl_b32 s58, s58, 13
  s_add_u32 s60, s60, s58
  s_lshl_b32 s59, s59, 7
  s_add_u32 s59, s59, s70
  s_add_u32 m0, s60, 0
  s_add_u32 s58, s59, 0
  buffer_load_dwordx4 v162, s[32:35], s58 offen lds
  s_waitcnt vmcnt(3)
  s_add_u32 m0, s60, 1024
  s_add_u32 s58, s59, 0
  buffer_load_dwordx4 v163, s[32:35], s58 offen lds
  s_waitcnt vmcnt(3)
  s_add_u32 m0, s60, 2048
  s_add_u32 s58, s59, 16384
  buffer_load_dwordx4 v162, s[32:35], s58 offen lds
  s_waitcnt vmcnt(3)
  s_add_u32 m0, s60, 3072
  s_add_u32 s58, s59, 16384
  buffer_load_dwordx4 v163, s[32:35], s58 offen lds
  s_waitcnt vmcnt(3)
  s_add_u32 s59, s4, 6
  s_and_b32 s59, s59, 7
  s_and_b32 s60, s59, 4
  s_lshl_b32 s60, s60, 14
  s_add_u32 s60, s60, s71
  s_and_b32 s58, s59, 3
  s_lshl_b32 s58, s58, 13
  s_add_u32 s60, s60, s58
  s_lshl_b32 s59, s59, 7
  s_add_u32 s59, s59, s70
  s_add_u32 m0, s60, 0
  s_add_u32 s58, s59, 0
  buffer_load_dwordx4 v162, s[32:35], s58 offen lds
  s_waitcnt vmcnt(3)
  s_add_u32 m0, s60, 1024
  s_add_u32 s58, s59, 0
  buffer_load_dwordx4 v163, s[32:35], s58 offen lds
  s_waitcnt vmcnt(3)
  s_add_u32 m0, s60, 2048
  s_add_u32 s58, s59, 16384
  buffer_load_dwordx4 v162, s[32:35], s58 offen lds
  s_waitcnt vmcnt(3)
  s_add_u32 m0, s60, 3072
  s_add_u32 s58, s59, 16384
  buffer_load_dwordx4 v163, s[32:35], s58 offen lds
  s_waitcnt vmcnt(3)
  s_add_u32 s59, s4, 7
  s_and_b32 s59, s59, 7
  s_and_b32 s60, s59, 4
  s_lshl_b32 s60, s60, 14
  s_add_u32 s60, s60, s71
  s_and_b32 s58, s59, 3
  s_lshl_b32 s58, s58, 13
  s_add_u32 s60, s60, s58
  s_lshl_b32 s59, s59, 7
  s_add_u32 s59, s59, s70
  s_add_u32 m0, s60, 0
  s_add_u32 s58, s59, 0
  buffer_load_dwordx4 v162, s[32:35], s58 offen lds
  s_waitcnt vmcnt(3)
  s_add_u32 m0, s60, 1024
  s_add_u32 s58, s59, 0
  buffer_load_dwordx4 v163, s[32:35], s58 offen lds
  s_waitcnt vmcnt(3)
  s_add_u32 m0, s60, 2048
  s_add_u32 s58, s59, 16384
  buffer_load_dwordx4 v162, s[32:35], s58 offen lds
  s_waitcnt vmcnt(3)
  s_add_u32 m0, s60, 3072
  s_add_u32 s58, s59, 16384
  buffer_load_dwordx4 v163, s[32:35], s58 offen lds
  s_waitcnt vmcnt(3)
  s_setprio 3
  v_xor_b32 v16, 8192, v31
  s_lshl_b32 s56, s55, 2
  s_add_u32 s56, s56, 163136
  v_mov_b32 v17, s56
  v_xor_b32 v18, 8, v17
  v_mov_b32 v19, 1
  s_lshl_b32 s54, s53, 1
  s_add_u32 s54, s54, s52
  s_lshl_b32 s62, s54, 14
  s_add_u32 s62, s62, 9437184
  s_lshl_b32 s54, s54, 15
  s_add_u32 s54, s54, 5242880
  s_lshl_b32 s48, s4, 10
  v_lshlrev_b32 v3, 7, v0
  s_add_u32 s48, s48, 69632
  v_add_u32 v3, s48, v3
  v_cmp_gt_u32 vcc, 8, v0
  s_mov_b32 s49, 0
  s_mov_b64 exec, vcc
Lpoll37:
  buffer_load_dword v4, v3, s[16:19], 0 offen sc0 sc1
  s_add_u32 s49, s49, 1
  s_waitcnt vmcnt(0)
  v_cmp_ne_u32 vcc, s6, v4
  s_cmp_gt_u32 s49, 200000
  s_cbranch_scc1 Lpollgo38
  s_cbranch_vccz Lpollgo38
  s_sleep 10
  s_branch Lpoll37
Lpollgo38:
  s_mov_b64 exec, -1
  s_waitcnt lgkmcnt(0)
  v_mov_b32 v3, 163084
  v_mov_b32 v4, 1
  s_mov_b64 exec, 1
  ds_add_u32 v3, v4
  s_mov_b64 exec, -1
  s_mov_b32 s49, 0
Llw39:
  ds_read_b32 v4, v3
  s_add_u32 s49, s49, 1
  s_waitcnt lgkmcnt(0)
  v_readfirstlane_b32 s50, v4
  s_cmp_gt_u32 s49, 1600000
  s_cbranch_scc1 Llwgo40
  s_cmp_ge_u32 s50, 8
  s_cbranch_scc1 Llwgo40
  s_sleep 4
  s_branch Llw39
Llwgo40:
  s_setprio 0
  buffer_load_dwordx4 v[64:67], v5, s[16:19], s54 offen offset:0 sc1
  buffer_load_dwordx4 v[68:71], v5, s[16:19], s54 offen offset:1024 sc1
  buffer_load_dwordx4 v[72:75], v5, s[16:19], s54 offen offset:2048 sc1
  buffer_load_dwordx4 v[76:79], v5, s[16:19], s54 offen offset:3072 sc1
  ds_read_b128 v[128:131], v152 offset:0
  ds_read_b128 v[132:135], v156 offset:0
  s_waitcnt vmcnt(3) lgkmcnt(0)
  s_setprio 3
  v_mfma_f32_32x32x16_bf16 v[32:47], v[64:67], v[128:131], v[32:47]
  v_mfma_f32_32x32x16_bf16 v[48:63], v[64:67], v[132:135], 0
  s_setprio 0
  s_add_u32 s54, s54, 4096
  buffer_load_dwordx4 v[80:83], v5, s[16:19], s54 offen offset:0 sc1
  ds_read_b128 v[128:131], v153 offset:0
  ds_read_b128 v[132:135], v157 offset:0
  s_waitcnt vmcnt(3) lgkmcnt(0)
  s_setprio 3
  v_mfma_f32_32x32x16_bf16 v[32:47], v[68:71], v[128:131], v[32:47]
  v_mfma_f32_32x32x16_bf16 v[48:63], v[68:71], v[132:135], v[48:63]
  s_setprio 0
  buffer_load_dwordx4 v[84:87], v5, s[16:19], s54 offen offset:1024 sc1
  ds_read_b128 v[128:131], v154 offset:0
  ds_read_b128 v[132:135], v158 offset:0
  s_waitcnt vmcnt(3) lgkmcnt(0)
  s_setprio 3
  v_mfma_f32_32x32x16_bf16 v[32:47], v[72:75], v[128:131], v[32:47]
  v_mfma_f32_32x32x16_bf16 v[48:63], v[72:75], v[132:135], v[48:63]
  s_setprio 0
  buffer_load_dwordx4 v[88:91], v5, s[16:19], s54 offen offset:2048 sc1
  ds_read_b128 v[128:131], v155 offset:0
  ds_read_b128 v[132:135], v159 offset:0
  s_waitcnt vmcnt(3) lgkmcnt(0)
  s_setprio 3
  v_mfma_f32_32x32x16_bf16 v[32:47], v[76:79], v[128:131], v[32:47]
  v_mfma_f32_32x32x16_bf16 v[48:63], v[76:79], v[132:135], v[48:63]
  s_setprio 0
  buffer_load_dwordx4 v[92:95], v5, s[16:19], s54 offen offset:3072 sc1
  ds_read_b128 v[128:131], v152 offset:8192
  ds_read_b128 v[132:135], v156 offset:8192
  s_waitcnt vmcnt(3) lgkmcnt(0)
  s_setprio 3
  v_mfma_f32_32x32x16_bf16 v[32:47], v[80:83], v[128:131], v[32:47]
  v_mfma_f32_32x32x16_bf16 v[48:63], v[80:83], v[132:135], v[48:63]
  s_setprio 0
  s_add_u32 s54, s54, 4096
  buffer_load_dwordx4 v[96:99], v5, s[16:19], s54 offen offset:0 sc1
  ds_read_b128 v[128:131], v153 offset:8192
  ds_read_b128 v[132:135], v157 offset:8192
  s_waitcnt vmcnt(3) lgkmcnt(0)
  s_setprio 3
  v_mfma_f32_32x32x16_bf16 v[32:47], v[84:87], v[128:131], v[32:47]
  v_mfma_f32_32x32x16_bf16 v[48:63], v[84:87], v[132:135], v[48:63]
  s_setprio 0
  buffer_load_dwordx4 v[100:103], v5, s[16:19], s54 offen offset:1024 sc1
  ds_read_b128 v[128:131], v154 offset:8192
  ds_read_b128 v[132:135], v158 offset:8192
  s_waitcnt vmcnt(3) lgkmcnt(0)
  s_setprio 3
  v_mfma_f32_32x32x16_bf16 v[32:47], v[88:91], v[128:131], v[32:47]
  v_mfma_f32_32x32x16_bf16 v[48:63], v[88:91], v[132:135], v[48:63]
  s_setprio 0
  buffer_load_dwordx4 v[104:107], v5, s[16:19], s54 offen offset:2048 sc1
  ds_read_b128 v[128:131], v155 offset:8192
  ds_read_b128 v[132:135], v159 offset:8192
  s_waitcnt vmcnt(3) lgkmcnt(0)
  s_setprio 3
  v_mfma_f32_32x32x16_bf16 v[32:47], v[92:95], v[128:131], v[32:47]
  v_mfma_f32_32x32x16_bf16 v[48:63], v[92:95], v[132:135], v[48:63]
  s_setprio 0
  buffer_load_dwordx4 v[108:111], v5, s[16:19], s54 offen offset:3072 sc1
  ds_read_b128 v[128:131], v152 offset:16384
  ds_read_b128 v[132:135], v156 offset:16384
  s_waitcnt vmcnt(3) lgkmcnt(0)
  s_setprio 3
  v_mfma_f32_32x32x16_bf16 v[32:47], v[96:99], v[128:131], v[32:47]
  v_mfma_f32_32x32x16_bf16 v[48:63], v[96:99], v[132:135], v[48:63]
  s_setprio 0
  s_add_u32 s54, s54, 4096
  buffer_load_dwordx4 v[112:115], v5, s[16:19], s54 offen offset:0 sc1
  ds_read_b128 v[128:131], v153 offset:16384
  ds_read_b128 v[132:135], v157 offset:16384
  s_waitcnt vmcnt(3) lgkmcnt(0)
  s_setprio 3
  v_mfma_f32_32x32x16_bf16 v[32:47], v[100:103], v[128:131], v[32:47]
  v_mfma_f32_32x32x16_bf16 v[48:63], v[100:103], v[132:135], v[48:63]
  s_setprio 0
  buffer_load_dwordx4 v[116:119], v5, s[16:19], s54 offen offset:1024 sc1
  ds_read_b128 v[128:131], v154 offset:16384
  ds_read_b128 v[132:135], v158 offset:16384
  s_waitcnt vmcnt(3) lgkmcnt(0)
  s_setprio 3
  v_mfma_f32_32x32x16_bf16 v[32:47], v[104:107], v[128:131], v[32:47]
  v_mfma_f32_32x32x16_bf16 v[48:63], v[104:107], v[132:135], v[48:63]
  s_setprio 0
  buffer_load_dwordx4 v[120:123], v5, s[16:19], s54 offen offset:2048 sc1
  ds_read_b128 v[128:131], v155 offset:16384
  ds_read_b128 v[132:135], v159 offset:16384
  s_waitcnt vmcnt(3) lgkmcnt(0)
  s_setprio 3
  v_mfma_f32_32x32x16_bf16 v[32:47], v[108:111], v[128:131], v[32:47]
  v_mfma_f32_32x32x16_bf16 v[48:63], v[108:111], v[132:135], v[48:63]
  s_setprio 0
  buffer_load_dwordx4 v[124:127], v5, s[16:19], s54 offen offset:3072 sc1
  ds_read_b128 v[128:131], v152 offset:24576
  ds_read_b128 v[132:135], v156 offset:24576
  s_waitcnt vmcnt(3) lgkmcnt(0)
  s_setprio 3
  v_mfma_f32_32x32x16_bf16 v[32:47], v[112:115], v[128:131], v[32:47]
  v_mfma_f32_32x32x16_bf16 v[48:63], v[112:115], v[132:135], v[48:63]
  s_setprio 0
  s_add_u32 s54, s54, 4096
  buffer_load_dwordx4 v[64:67], v5, s[16:19], s54 offen offset:0 sc1
  ds_read_b128 v[128:131], v153 offset:24576
  ds_read_b128 v[132:135], v157 offset:24576
  s_waitcnt vmcnt(3) lgkmcnt(0)
  s_setprio 3
  v_mfma_f32_32x32x16_bf16 v[32:47], v[116:119], v[128:131], v[32:47]
  v_mfma_f32_32x32x16_bf16 v[48:63], v[116:119], v[132:135], v[48:63]
  s_setprio 0
  buffer_load_dwordx4 v[68:71], v5, s[16:19], s54 offen offset:1024 sc1
  ds_read_b128 v[128:131], v154 offset:24576
  ds_read_b128 v[132:135], v158 offset:24576
  s_waitcnt vmcnt(3) lgkmcnt(0)
  s_setprio 3
  v_mfma_f32_32x32x16_bf16 v[32:47], v[120:123], v[128:131], v[32:47]
  v_mfma_f32_32x32x16_bf16 v[48:63], v[120:123], v[132:135], v[48:63]
  s_setprio 0
  buffer_load_dwordx4 v[72:75], v5, s[16:19], s54 offen offset:2048 sc1
  ds_read_b128 v[128:131], v155 offset:24576
  ds_read_b128 v[132:135], v159 offset:24576
  s_waitcnt vmcnt(3) lgkmcnt(0)
  s_setprio 3
  v_mfma_f32_32x32x16_bf16 v[32:47], v[124:127], v[128:131], v[32:47]
  v_mfma_f32_32x32x16_bf16 v[48:63], v[124:127], v[132:135], v[48:63]
  s_setprio 0
  buffer_load_dwordx4 v[76:79], v5, s[16:19], s54 offen offset:3072 sc1
  s_setprio 3
  v_add_u32 v152, 65536, v152
  v_add_u32 v156, 65536, v156
  v_add_u32 v153, 65536, v153
  v_add_u32 v157, 65536, v157
  v_add_u32 v154, 65536, v154
  v_add_u32 v158, 65536, v158
  v_add_u32 v155, 65536, v155
  v_add_u32 v159, 65536, v159
  s_waitcnt lgkmcnt(0)
  v_mov_b32 v3, 163084
  v_mov_b32 v4, 1
  s_mov_b64 exec, 1
  ds_add_u32 v3, v4
  s_mov_b64 exec, -1
  s_mov_b32 s49, 0
Llw41:
  ds_read_b32 v4, v3
  s_add_u32 s49, s49, 1
  s_waitcnt lgkmcnt(0)
  v_readfirstlane_b32 s50, v4
  s_cmp_gt_u32 s49, 1600000
  s_cbranch_scc1 Llwgo42
  s_cmp_ge_u32 s50, 12
  s_cbranch_scc1 Llwgo42
  s_sleep 4
  s_branch Llw41
Llwgo42:
  s_lshl_b32 s56, s5, 7
  s_lshl_b32 s57, s55, 11
  s_setprio 0
  s_add_u32 s54, s54, 4096
  buffer_load_dwordx4 v[80:83], v5, s[16:19], s54 offen offset:0 sc1
  s_waitcnt vmcnt(3)
  buffer_load_dwordx4 v[84:87], v5, s[16:19], s54 offen offset:1024 sc1
  s_waitcnt vmcnt(3)
  buffer_load_dwordx4 v[88:91], v5, s[16:19], s54 offen offset:2048 sc1
  s_waitcnt vmcnt(3)
  buffer_load_dwordx4 v[92:95], v5, s[16:19], s54 offen offset:3072 sc1
  s_waitcnt vmcnt(3)
  s_add_u32 s54, s54, 4096
  buffer_load_dwordx4 v[96:99], v5, s[16:19], s54 offen offset:0 sc1
  s_waitcnt vmcnt(3)
  buffer_load_dwordx4 v[100:103], v5, s[16:19], s54 offen offset:1024 sc1
  s_waitcnt vmcnt(3)
  buffer_load_dwordx4 v[104:107], v5, s[16:19], s54 offen offset:2048 sc1
  s_waitcnt vmcnt(3)
  buffer_load_dwordx4 v[108:111], v5, s[16:19], s54 offen offset:3072 sc1
  s_waitcnt vmcnt(3)
  s_add_u32 s54, s54, 4096
  buffer_load_dwordx4 v[112:115], v5, s[16:19], s54 offen offset:0 sc1
  s_waitcnt vmcnt(3)
  buffer_load_dwordx4 v[116:119], v5, s[16:19], s54 offen offset:1024 sc1
  s_waitcnt vmcnt(3)
  buffer_load_dwordx4 v[120:123], v5, s[16:19], s54 offen offset:2048 sc1
  s_waitcnt vmcnt(3)
  buffer_load_dwordx4 v[124:127], v5, s[16:19], s54 offen offset:3072 sc1
  s_waitcnt vmcnt(3)
  s_add_u32 s59, s4, 0
  s_and_b32 s59, s59, 7
  s_lshl_b32 s60, s59, 13
  s_add_u32 s60, s60, s57
  s_lshl_b32 s59, s59, 16
  s_add_u32 s59, s59, s56
  s_add_u32 m0, s60, 0
  s_add_u32 s58, s59, 0
  buffer_load_dwordx4 v164, s[36:39], s58 offen lds
  s_waitcnt vmcnt(3)
  s_add_u32 m0, s60, 1024
  s_add_u32 s58, s59, 8192
  buffer_load_dwordx4 v164, s[36:39], s58 offen lds
  s_waitcnt vmcnt(3)
  s_add_u32 s59, s4, 1
  s_and_b32 s59, s59, 7
  s_lshl_b32 s60, s59, 13
  s_add_u32 s60, s60, s57
  s_lshl_b32 s59, s59, 16
  s_add_u32 s59, s59, s56
  s_add_u32 m0, s60, 0
  s_add_u32 s58, s59, 0
  buffer_load_dwordx4 v164, s[36:39], s58 offen lds
  s_waitcnt vmcnt(3)
  s_add_u32 m0, s60, 1024
  s_add_u32 s58, s59, 8192
  buffer_load_dwordx4 v164, s[36:39], s58 offen lds
  s_waitcnt vmcnt(3)
  s_add_u32 s59, s4, 2
  s_and_b32 s59, s59, 7
  s_lshl_b32 s60, s59, 13
  s_add_u32 s60, s60, s57
  s_lshl_b32 s59, s59, 16
  s_add_u32 s59, s59, s56
  s_add_u32 m0, s60, 0
  s_add_u32 s58, s59, 0
  buffer_load_dwordx4 v164, s[36:39], s58 offen lds
  s_waitcnt vmcnt(3)
  s_add_u32 m0, s60, 1024
  s_add_u32 s58, s59, 8192
  buffer_load_dwordx4 v164, s[36:39], s58 offen lds
  s_waitcnt vmcnt(3)
  s_add_u32 s59, s4, 3
  s_and_b32 s59, s59, 7
  s_lshl_b32 s60, s59, 13
  s_add_u32 s60, s60, s57
  s_lshl_b32 s59, s59, 16
  s_add_u32 s59, s59, s56
  s_add_u32 m0, s60, 0
  s_add_u32 s58, s59, 0
  buffer_load_dwordx4 v164, s[36:39], s58 offen lds
  s_waitcnt vmcnt(3)
  s_add_u32 m0, s60, 1024
  s_add_u32 s58, s59, 8192
  buffer_load_dwordx4 v164, s[36:39], s58 offen lds
  s_waitcnt vmcnt(3)
  s_add_u32 s59, s4, 4
  s_and_b32 s59, s59, 7
  s_lshl_b32 s60, s59, 13
  s_add_u32 s60, s60, s57
  s_lshl_b32 s59, s59, 16
  s_add_u32 s59, s59, s56
  s_add_u32 m0, s60, 0
  s_add_u32 s58, s59, 0
  buffer_load_dwordx4 v164, s[36:39], s58 offen lds
  s_waitcnt vmcnt(3)
  s_add_u32 m0, s60, 1024
  s_add_u32 s58, s59, 8192
  buffer_load_dwordx4 v164, s[36:39], s58 offen lds
  s_waitcnt vmcnt(3)
  s_add_u32 s59, s4, 5
  s_and_b32 s59, s59, 7
  s_lshl_b32 s60, s59, 13
  s_add_u32 s60, s60, s57
  s_lshl_b32 s59, s59, 16
  s_add_u32 s59, s59, s56
  s_add_u32 m0, s60, 0
  s_add_u32 s58, s59, 0
  buffer_load_dwordx4 v164, s[36:39], s58 offen lds
  s_waitcnt vmcnt(3)
  s_add_u32 m0, s60, 1024
  s_add_u32 s58, s59, 8192
  buffer_load_dwordx4 v164, s[36:39], s58 offen lds
  s_waitcnt vmcnt(3)
  s_add_u32 s59, s4, 6
  s_and_b32 s59, s59, 7
  s_lshl_b32 s60, s59, 13
  s_add_u32 s60, s60, s57
  s_lshl_b32 s59, s59, 16
  s_add_u32 s59, s59, s56
  s_add_u32 m0, s60, 0
  s_add_u32 s58, s59, 0
  buffer_load_dwordx4 v164, s[36:39], s58 offen lds
  s_waitcnt vmcnt(3)
  s_add_u32 m0, s60, 1024
  s_add_u32 s58, s59, 8192
  buffer_load_dwordx4 v164, s[36:39], s58 offen lds
  s_waitcnt vmcnt(3)
  s_add_u32 s59, s4, 7
  s_and_b32 s59, s59, 7
  s_lshl_b32 s60, s59, 13
  s_add_u32 s60, s60, s57
  s_lshl_b32 s59, s59, 16
  s_add_u32 s59, s59, s56
  s_add_u32 m0, s60, 0
  s_add_u32 s58, s59, 0
  buffer_load_dwordx4 v164, s[36:39], s58 offen lds
  s_waitcnt vmcnt(3)
  s_add_u32 m0, s60, 1024
  s_add_u32 s58, s59, 8192
  buffer_load_dwordx4 v164, s[36:39], s58 offen lds
  s_waitcnt vmcnt(3)
  s_setprio 3
  s_waitcnt vmcnt(0)
  s_waitcnt lgkmcnt(0)
  v_mov_b32 v3, 163084
  v_mov_b32 v4, 1
  s_mov_b64 exec, 1
  ds_add_u32 v3, v4
  s_mov_b64 exec, -1
  s_mov_b32 s49, 0
Llw43:
  ds_read_b32 v4, v3
  s_add_u32 s49, s49, 1
  s_waitcnt lgkmcnt(0)
  v_readfirstlane_b32 s50, v4
  s_cmp_gt_u32 s49, 1600000
  s_cbranch_scc1 Llwgo44
  s_cmp_ge_u32 s50, 16
  s_cbranch_scc1 Llwgo44
  s_sleep 4
  s_branch Llw43
Llwgo44:
  ds_read_b128 v[128:131], v152 offset:0
  ds_read_b128 v[132:135], v156 offset:0
  ds_read_b128 v[136:139], v153 offset:0
  ds_read_b128 v[140:143], v157 offset:0
  ds_read_b128 v[144:147], v154 offset:0
  ds_read_b128 v[148:151], v158 offset:0
  v_mov_b32 v3, 163088
  s_mov_b32 s49, 0
Llw45:
  ds_read_b32 v4, v3
  s_add_u32 s49, s49, 1
  s_waitcnt lgkmcnt(0)
  v_readfirstlane_b32 s50, v4
  s_cmp_gt_u32 s49, 1600000
  s_cbranch_scc1 Llwgo46
  s_cmp_ge_u32 s50, 8
  s_cbranch_scc1 Llwgo46
  s_sleep 2
  s_branch Llw45
Llwgo46:
  s_mov_b32 s49, 0
  ds_read_b128 v[8:11], v155 offset:0
  ds_read_b128 v[12:15], v159 offset:0
  s_waitcnt lgkmcnt(6)
  v_mfma_f32_32x32x16_bf16 v[32:47], v[64:67], v[128:131], v[32:47]
  v_mfma_f32_32x32x16_bf16 v[48:63], v[64:67], v[132:135], v[48:63]
  s_add_u32 s56, s62, 0
  buffer_load_dwordx4 v[64:67], v5, s[16:19], s56 offen offset:0 sc0 sc1
  ds_read_b128 v[128:131], v152 offset:8192
  ds_read_b128 v[132:135], v156 offset:8192
  s_waitcnt lgkmcnt(6)
  v_mfma_f32_32x32x16_bf16 v[32:47], v[68:71], v[136:139], v[32:47]
  v_mfma_f32_32x32x16_bf16 v[48:63], v[68:71], v[140:143], v[48:63]
  s_add_u32 s56, s62, 0
  buffer_load_dwordx4 v[68:71], v5, s[16:19], s56 offen offset:1024 sc0 sc1
  ds_read_b128 v[136:139], v153 offset:8192
  ds_read_b128 v[140:143], v157 offset:8192
  s_waitcnt lgkmcnt(6)
  v_mfma_f32_32x32x16_bf16 v[32:47], v[72:75], v[144:147], v[32:47]
  v_mfma_f32_32x32x16_bf16 v[48:63], v[72:75], v[148:151], v[48:63]
  s_add_u32 s56, s62, 0
  buffer_load_dwordx4 v[72:75], v5, s[16:19], s56 offen offset:2048 sc0 sc1
  ds_read_b128 v[144:147], v154 offset:8192
  ds_read_b128 v[148:151], v158 offset:8192
  s_waitcnt lgkmcnt(6)
  v_mfma_f32_32x32x16_bf16 v[32:47], v[76:79], v[8:11], v[32:47]
  v_mfma_f32_32x32x16_bf16 v[48:63], v[76:79], v[12:15], v[48:63]
  s_add_u32 s56, s62, 0
  buffer_load_dwordx4 v[76:79], v5, s[16:19], s56 offen offset:3072 sc0 sc1
  ds_read_b128 v[8:11], v155 offset:8192
  ds_read_b128 v[12:15], v159 offset:8192
  s_waitcnt lgkmcnt(6)
  v_mfma_f32_32x32x16_bf16 v[32:47], v[80:83], v[128:131], v[32:47]
  v_mfma_f32_32x32x16_bf16 v[48:63], v[80:83], v[132:135], v[48:63]
  s_add_u32 s56, s62, 4096
  buffer_load_dwordx4 v[80:83], v5, s[16:19], s56 offen offset:0 sc0 sc1
  ds_read_b128 v[128:131], v152 offset:16384
  ds_read_b128 v[132:135], v156 offset:16384
  s_waitcnt lgkmcnt(6)
  v_mfma_f32_32x32x16_bf16 v[32:47], v[84:87], v[136:139], v[32:47]
  v_mfma_f32_32x32x16_bf16 v[48:63], v[84:87], v[140:143], v[48:63]
  s_add_u32 s56, s62, 4096
  buffer_load_dwordx4 v[84:87], v5, s[16:19], s56 offen offset:1024 sc0 sc1
  ds_read_b128 v[136:139], v153 offset:16384
  ds_read_b128 v[140:143], v157 offset:16384
  s_waitcnt lgkmcnt(6)
  v_mfma_f32_32x32x16_bf16 v[32:47], v[88:91], v[144:147], v[32:47]
  v_mfma_f32_32x32x16_bf16 v[48:63], v[88:91], v[148:151], v[48:63]
  s_add_u32 s56, s62, 4096
  buffer_load_dwordx4 v[88:91], v5, s[16:19], s56 offen offset:2048 sc0 sc1
  ds_read_b128 v[144:147], v154 offset:16384
  ds_read_b128 v[148:151], v158 offset:16384
  s_waitcnt lgkmcnt(6)
  v_mfma_f32_32x32x16_bf16 v[32:47], v[92:95], v[8:11], v[32:47]
  v_mfma_f32_32x32x16_bf16 v[48:63], v[92:95], v[12:15], v[48:63]
  s_add_u32 s56, s62, 4096
  buffer_load_dwordx4 v[92:95], v5, s[16:19], s56 offen offset:3072 sc0 sc1
  ds_read_b128 v[8:11], v155 offset:16384
  ds_read_b128 v[12:15], v159 offset:16384
  s_waitcnt lgkmcnt(6)
  v_mfma_f32_32x32x16_bf16 v[32:47], v[96:99], v[128:131], v[32:47]
  v_mfma_f32_32x32x16_bf16 v[48:63], v[96:99], v[132:135], v[48:63]
  s_add_u32 s56, s62, 8192
  buffer_load_dwordx4 v[96:99], v5, s[16:19], s56 offen offset:0 sc0 sc1
  ds_read_b128 v[128:131], v152 offset:24576
  ds_read_b128 v[132:135], v156 offset:24576
  s_waitcnt lgkmcnt(6)
  v_mfma_f32_32x32x16_bf16 v[32:47], v[100:103], v[136:139], v[32:47]
  v_mfma_f32_32x32x16_bf16 v[48:63], v[100:103], v[140:143], v[48:63]
  s_add_u32 s56, s62, 8192
  buffer_load_dwordx4 v[100:103], v5, s[16:19], s56 offen offset:1024 sc0 sc1
  ds_read_b128 v[136:139], v153 offset:24576
  ds_read_b128 v[140:143], v157 offset:24576
  s_waitcnt lgkmcnt(6)
  v_mfma_f32_32x32x16_bf16 v[32:47], v[104:107], v[144:147], v[32:47]
  v_mfma_f32_32x32x16_bf16 v[48:63], v[104:107], v[148:151], v[48:63]
  s_add_u32 s56, s62, 8192
  buffer_load_dwordx4 v[104:107], v5, s[16:19], s56 offen offset:2048 sc0 sc1
  ds_read_b128 v[144:147], v154 offset:24576
  ds_read_b128 v[148:151], v158 offset:24576
  s_waitcnt lgkmcnt(6)
  v_mfma_f32_32x32x16_bf16 v[32:47], v[108:111], v[8:11], v[32:47]
  v_mfma_f32_32x32x16_bf16 v[48:63], v[108:111], v[12:15], v[48:63]
  s_add_u32 s56, s62, 8192
  buffer_load_dwordx4 v[108:111], v5, s[16:19], s56 offen offset:3072 sc0 sc1
  ds_read_b128 v[8:11], v155 offset:24576
  ds_read_b128 v[12:15], v159 offset:24576
  s_waitcnt lgkmcnt(6)
  v_mfma_f32_32x32x16_bf16 v[32:47], v[112:115], v[128:131], v[32:47]
  v_mfma_f32_32x32x16_bf16 v[48:63], v[112:115], v[132:135], v[48:63]
  s_add_u32 s56, s62, 12288
  buffer_load_dwordx4 v[112:115], v5, s[16:19], s56 offen offset:0 sc0 sc1
  ds_read_b64_tr_b16 v[128:129], v165 offset:0
  ds_read_b64_tr_b16 v[130:131], v165 offset:1024
  ds_read_b64_tr_b16 v[132:133], v161 offset:0
  ds_read_b64_tr_b16 v[134:135], v161 offset:1024
  s_waitcnt lgkmcnt(8)
  v_mfma_f32_32x32x16_bf16 v[32:47], v[116:119], v[136:139], v[32:47]
  v_mfma_f32_32x32x16_bf16 v[48:63], v[116:119], v[140:143], v[48:63]
  s_add_u32 s56, s62, 12288
  buffer_load_dwordx4 v[116:119], v5, s[16:19], s56 offen offset:1024 sc0 sc1
  ds_read_b64_tr_b16 v[136:137], v165 offset:2048
  ds_read_b64_tr_b16 v[138:139], v165 offset:3072
  ds_read_b64_tr_b16 v[140:141], v161 offset:2048
  ds_read_b64_tr_b16 v[142:143], v161 offset:3072
  s_waitcnt lgkmcnt(10)
  v_mfma_f32_32x32x16_bf16 v[32:47], v[120:123], v[144:147], v[32:47]
  v_mfma_f32_32x32x16_bf16 v[48:63], v[120:123], v[148:151], v[48:63]
  s_add_u32 s56, s62, 12288
  buffer_load_dwordx4 v[120:123], v5, s[16:19], s56 offen offset:2048 sc0 sc1
  ds_read_b64_tr_b16 v[144:145], v165 offset:4096
  ds_read_b64_tr_b16 v[146:147], v165 offset:5120
  ds_read_b64_tr_b16 v[148:149], v161 offset:4096
  ds_read_b64_tr_b16 v[150:151], v161 offset:5120
  s_waitcnt lgkmcnt(12)
  v_mfma_f32_32x32x16_bf16 v[32:47], v[124:127], v[8:11], v[32:47]
  v_mfma_f32_32x32x16_bf16 v[48:63], v[124:127], v[12:15], v[48:63]
  s_add_u32 s56, s62, 12288
  buffer_load_dwordx4 v[124:127], v5, s[16:19], s56 offen offset:3072 sc0 sc1
L_ck0:
  s_waitcnt vmcnt(15)
  v_max3_u32 v3, v64, v65, v66
  v_max_u32 v3, v3, v67
  v_cmp_eq_u32 vcc, -1, v3
  s_cbranch_vccnz L_or0
L_ok0:
  s_waitcnt lgkmcnt(8)
  v_mfma_f32_32x32x16_bf16 v[48:63], v[64:67], v[132:135], v[48:63]
  s_waitcnt vmcnt(14)
  v_max3_u32 v3, v68, v69, v70
  v_max_u32 v3, v3, v71
  v_cmp_eq_u32 vcc, -1, v3
  v_mfma_f32_32x32x16_bf16 v[32:47], v[64:67], v[128:131], v[32:47]
  ds_read_b64_tr_b16 v[8:9], v165 offset:6144
  ds_read_b64_tr_b16 v[10:11], v165 offset:7168
  ds_read_b64_tr_b16 v[12:13], v161 offset:6144
  ds_read_b64_tr_b16 v[14:15], v161 offset:7168
  s_cbranch_vccnz L_or1
L_ok1:
  s_waitcnt lgkmcnt(8)
  v_mfma_f32_32x32x16_bf16 v[48:63], v[68:71], v[140:143], v[48:63]
  s_waitcnt vmcnt(13)
  v_max3_u32 v3, v72, v73, v74
  v_max_u32 v3, v3, v75
  v_cmp_eq_u32 vcc, -1, v3
  v_mfma_f32_32x32x16_bf16 v[32:47], v[68:71], v[136:139], v[32:47]
  ds_read_b64_tr_b16 v[128:129], v165 offset:8192
  ds_read_b64_tr_b16 v[130:131], v165 offset:9216
  ds_read_b64_tr_b16 v[132:133], v161 offset:8192
  ds_read_b64_tr_b16 v[134:135], v161 offset:9216
  s_cbranch_vccnz L_or2
L_ok2:
  s_waitcnt lgkmcnt(8)
  v_mfma_f32_32x32x16_bf16 v[48:63], v[72:75], v[148:151], v[48:63]
  s_waitcnt vmcnt(12)
  v_max3_u32 v3, v76, v77, v78
  v_max_u32 v3, v3, v79
  v_cmp_eq_u32 vcc, -1, v3
  v_mfma_f32_32x32x16_bf16 v[32:47], v[72:75], v[144:147], v[32:47]
  ds_read_b64_tr_b16 v[136:137], v165 offset:10240
  ds_read_b64_tr_b16 v[138:139], v165 offset:11264
  ds_read_b64_tr_b16 v[140:141], v161 offset:10240
  ds_read_b64_tr_b16 v[142:143], v161 offset:11264
  s_cbranch_vccnz L_or3
L_ok3:
  s_waitcnt lgkmcnt(8)
  v_mfma_f32_32x32x16_bf16 v[48:63], v[76:79], v[12:15], v[48:63]
  s_waitcnt vmcnt(11)
  v_max3_u32 v3, v80, v81, v82
  v_max_u32 v3, v3, v83
  v_cmp_eq_u32 vcc, -1, v3
  v_mfma_f32_32x32x16_bf16 v[32:47], v[76:79], v[8:11], v[32:47]
  ds_read_b64_tr_b16 v[144:145], v165 offset:12288
  ds_read_b64_tr_b16 v[146:147], v165 offset:13312
  ds_read_b64_tr_b16 v[148:149], v161 offset:12288
  ds_read_b64_tr_b16 v[150:151], v161 offset:13312
  s_cbranch_vccnz L_or4
L_ok4:
  s_waitcnt lgkmcnt(8)
  v_mfma_f32_32x32x16_bf16 v[48:63], v[80:83], v[132:135], v[48:63]
  s_waitcnt vmcnt(10)
  v_max3_u32 v3, v84, v85, v86
  v_max_u32 v3, v3, v87
  v_cmp_eq_u32 vcc, -1, v3
  v_mfma_f32_32x32x16_bf16 v[32:47], v[80:83], v[128:131], v[32:47]
  ds_read_b64_tr_b16 v[8:9], v165 offset:14336
  ds_read_b64_tr_b16 v[10:11], v165 offset:15360
  ds_read_b64_tr_b16 v[12:13], v161 offset:14336
  ds_read_b64_tr_b16 v[14:15], v161 offset:15360
  s_cbranch_vccnz L_or5
L_ok5:
  s_waitcnt lgkmcnt(8)
  v_mfma_f32_32x32x16_bf16 v[48:63], v[84:87], v[140:143], v[48:63]
  s_waitcnt vmcnt(9)
  v_max3_u32 v3, v88, v89, v90
  v_max_u32 v3, v3, v91
  v_cmp_eq_u32 vcc, -1, v3
  v_mfma_f32_32x32x16_bf16 v[32:47], v[84:87], v[136:139], v[32:47]
  ds_read_b64_tr_b16 v[128:129], v165 offset:16384
  ds_read_b64_tr_b16 v[130:131], v165 offset:17408
  ds_read_b64_tr_b16 v[132:133], v161 offset:16384
  ds_read_b64_tr_b16 v[134:135], v161 offset:17408
  s_cbranch_vccnz L_or6
L_ok6:
  s_waitcnt lgkmcnt(8)
  v_mfma_f32_32x32x16_bf16 v[48:63], v[88:91], v[148:151], v[48:63]
  s_waitcnt vmcnt(8)
  v_max3_u32 v3, v92, v93, v94
  v_max_u32 v3, v3, v95
  v_cmp_eq_u32 vcc, -1, v3
  v_mfma_f32_32x32x16_bf16 v[32:47], v[88:91], v[144:147], v[32:47]
  ds_read_b64_tr_b16 v[136:137], v165 offset:18432
  ds_read_b64_tr_b16 v[138:139], v165 offset:19456
  ds_read_b64_tr_b16 v[140:141], v161 offset:18432
  ds_read_b64_tr_b16 v[142:143], v161 offset:19456
  s_cbranch_vccnz L_or7
L_ok7:
  s_waitcnt lgkmcnt(8)
  v_mfma_f32_32x32x16_bf16 v[48:63], v[92:95], v[12:15], v[48:63]
  s_waitcnt vmcnt(7)
  v_max3_u32 v3, v96, v97, v98
  v_max_u32 v3, v3, v99
  v_cmp_eq_u32 vcc, -1, v3
  v_mfma_f32_32x32x16_bf16 v[32:47], v[92:95], v[8:11], v[32:47]
  ds_read_b64_tr_b16 v[144:145], v165 offset:20480
  ds_read_b64_tr_b16 v[146:147], v165 offset:21504
  ds_read_b64_tr_b16 v[148:149], v161 offset:20480
  ds_read_b64_tr_b16 v[150:151], v161 offset:21504
  s_cbranch_vccnz L_or8
L_ok8:
  s_waitcnt lgkmcnt(8)
  v_mfma_f32_32x32x16_bf16 v[48:63], v[96:99], v[132:135], v[48:63]
  s_waitcnt vmcnt(6)
  v_max3_u32 v3, v100, v101, v102
  v_max_u32 v3, v3, v103
  v_cmp_eq_u32 vcc, -1, v3
  v_mfma_f32_32x32x16_bf16 v[32:47], v[96:99], v[128:131], v[32:47]
  ds_read_b64_tr_b16 v[8:9], v165 offset:22528
  ds_read_b64_tr_b16 v[10:11], v165 offset:23552
  ds_read_b64_tr_b16 v[12:13], v161 offset:22528
  ds_read_b64_tr_b16 v[14:15], v161 offset:23552
  s_cbranch_vccnz L_or9
L_ok9:
  s_waitcnt lgkmcnt(8)
  v_mfma_f32_32x32x16_bf16 v[48:63], v[100:103], v[140:143], v[48:63]
  s_waitcnt vmcnt(5)
  v_max3_u32 v3, v104, v105, v106
  v_max_u32 v3, v3, v107
  v_cmp_eq_u32 vcc, -1, v3
  v_mfma_f32_32x32x16_bf16 v[32:47], v[100:103], v[136:139], v[32:47]
  ds_read_b64_tr_b16 v[128:129], v165 offset:24576
  ds_read_b64_tr_b16 v[130:131], v165 offset:25600
  ds_read_b64_tr_b16 v[132:133], v161 offset:24576
  ds_read_b64_tr_b16 v[134:135], v161 offset:25600
  s_cbranch_vccnz L_or10
L_ok10:
  s_waitcnt lgkmcnt(8)
  v_mfma_f32_32x32x16_bf16 v[48:63], v[104:107], v[148:151], v[48:63]
  s_waitcnt vmcnt(4)
  v_max3_u32 v3, v108, v109, v110
  v_max_u32 v3, v3, v111
  v_cmp_eq_u32 vcc, -1, v3
  v_mfma_f32_32x32x16_bf16 v[32:47], v[104:107], v[144:147], v[32:47]
  ds_read_b64_tr_b16 v[136:137], v165 offset:26624
  ds_read_b64_tr_b16 v[138:139], v165 offset:27648
  ds_read_b64_tr_b16 v[140:141], v161 offset:26624
  ds_read_b64_tr_b16 v[142:143], v161 offset:27648
  s_cbranch_vccnz L_or11
L_ok11:
  s_waitcnt lgkmcnt(8)
  v_mfma_f32_32x32x16_bf16 v[48:63], v[108:111], v[12:15], v[48:63]
  s_waitcnt vmcnt(3)
  v_max3_u32 v3, v112, v113, v114
  v_max_u32 v3, v3, v115
  v_cmp_eq_u32 vcc, -1, v3
  v_mfma_f32_32x32x16_bf16 v[32:47], v[108:111], v[8:11], v[32:47]
  ds_read_b64_tr_b16 v[144:145], v165 offset:28672
  ds_read_b64_tr_b16 v[146:147], v165 offset:29696
  ds_read_b64_tr_b16 v[148:149], v161 offset:28672
  ds_read_b64_tr_b16 v[150:151], v161 offset:29696
  s_cbranch_vccnz L_or12
L_ok12:
  s_waitcnt lgkmcnt(8)
  v_mfma_f32_32x32x16_bf16 v[48:63], v[112:115], v[132:135], v[48:63]
  s_waitcnt vmcnt(2)
  v_max3_u32 v3, v116, v117, v118
  v_max_u32 v3, v3, v119
  v_cmp_eq_u32 vcc, -1, v3
  v_mfma_f32_32x32x16_bf16 v[32:47], v[112:115], v[128:131], v[32:47]
  ds_read_b64_tr_b16 v[8:9], v165 offset:30720
  ds_read_b64_tr_b16 v[10:11], v165 offset:31744
  ds_read_b64_tr_b16 v[12:13], v161 offset:30720
  ds_read_b64_tr_b16 v[14:15], v161 offset:31744
  s_cbranch_vccnz L_or13
L_ok13:
  s_waitcnt lgkmcnt(8)
  v_mfma_f32_32x32x16_bf16 v[48:63], v[116:119], v[140:143], v[48:63]
  s_waitcnt vmcnt(1)
  v_max3_u32 v3, v120, v121, v122
  v_max_u32 v3, v3, v123
  v_cmp_eq_u32 vcc, -1, v3
  v_mfma_f32_32x32x16_bf16 v[32:47], v[116:119], v[136:139], v[32:47]
  s_cbranch_vccnz L_or14
L_ok14:
  s_waitcnt lgkmcnt(4)
  v_mfma_f32_32x32x16_bf16 v[48:63], v[120:123], v[148:151], v[48:63]
  s_waitcnt vmcnt(0)
  v_max3_u32 v3, v124, v125, v126
  v_max_u32 v3, v3, v127
  v_cmp_eq_u32 vcc, -1, v3
  v_mfma_f32_32x32x16_bf16 v[32:47], v[120:123], v[144:147], v[32:47]
  s_cbranch_vccnz L_or15
L_ok15:
  s_waitcnt lgkmcnt(0)
  v_mfma_f32_32x32x16_bf16 v[48:63], v[124:127], v[12:15], v[48:63]
  v_mfma_f32_32x32x16_bf16 v[32:47], v[124:127], v[8:11], v[32:47]
  s_nop 10
  ds_write_b128 v31, v[48:51] offset:0
  ds_write_b128 v31, v[52:55] offset:1024
  ds_write_b128 v31, v[56:59] offset:2048
  ds_write_b128 v31, v[60:63] offset:3072
  ds_write_b32 v17, v19
  s_mov_b32 s49, 0
Lpg47:
  ds_read_b32 v19, v18
  ds_read_b128 v[64:67], v16 offset:0
  ds_read_b128 v[68:71], v16 offset:1024
  ds_read_b128 v[72:75], v16 offset:2048
  ds_read_b128 v[76:79], v16 offset:3072
  s_add_u32 s49, s49, 1
  s_waitcnt lgkmcnt(0)
  v_readfirstlane_b32 s50, v19
  s_cmp_gt_u32 s49, 1600000
  s_cbranch_scc1 Lpggo48
  s_cmp_eq_u32 s50, 0
  s_cbranch_scc1 Lpg47
Lpggo48:
  v_add_f32 v32, v32, v64
  buffer_store_dword v32, v30, s[20:23], 0 offen offset:0 sc1
  v_add_f32 v33, v33, v65
  buffer_store_dword v33, v30, s[20:23], 0 offen offset:2048 sc1
  v_add_f32 v34, v34, v66
  v_add_u32 v30, 4096, v30
  buffer_store_dword v34, v30, s[20:23], 0 offen offset:0 sc1
  v_add_f32 v35, v35, v67
  buffer_store_dword v35, v30, s[20:23], 0 offen offset:2048 sc1
  v_add_f32 v36, v36, v68
  v_add_u32 v30, 4096, v30
  buffer_store_dword v36, v30, s[20:23], 0 offen offset:0 sc1
  v_add_f32 v37, v37, v69
  buffer_store_dword v37, v30, s[20:23], 0 offen offset:2048 sc1
  v_add_f32 v38, v38, v70
  v_add_u32 v30, 4096, v30
  buffer_store_dword v38, v30, s[20:23], 0 offen offset:0 sc1
  v_add_f32 v39, v39, v71
  buffer_store_dword v39, v30, s[20:23], 0 offen offset:2048 sc1
  v_add_f32 v40, v40, v72
  v_add_u32 v30, 4096, v30
  buffer_store_dword v40, v30, s[20:23], 0 offen offset:0 sc1
  v_add_f32 v41, v41, v73
  buffer_store_dword v41, v30, s[20:23], 0 offen offset:2048 sc1
  v_add_f32 v42, v42, v74
  v_add_u32 v30, 4096, v30
  buffer_store_dword v42, v30, s[20:23], 0 offen offset:0 sc1
  v_add_f32 v43, v43, v75
  buffer_store_dword v43, v30, s[20:23], 0 offen offset:2048 sc1
  v_add_f32 v44, v44, v76
  v_add_u32 v30, 4096, v30
  buffer_store_dword v44, v30, s[20:23], 0 offen offset:0 sc1
  v_add_f32 v45, v45, v77
  buffer_store_dword v45, v30, s[20:23], 0 offen offset:2048 sc1
  v_add_f32 v46, v46, v78
  v_add_u32 v30, 4096, v30
  buffer_store_dword v46, v30, s[20:23], 0 offen offset:0 sc1
  v_add_f32 v47, v47, v79
  buffer_store_dword v47, v30, s[20:23], 0 offen offset:2048 sc1
  s_or_b32 s56, s4, s5
  s_or_b32 s56, s56, s55
  s_cmp_eq_u32 s56, 0
  s_cbranch_scc0 L_exit
  v_mov_b32 v3, 0
  v_mov_b32 v4, s6
  s_mov_b64 exec, 1
  buffer_store_dword v4, v3, s[16:19], 0 offen
  s_endpgm
L_or0:
  s_add_u32 s49, s49, 1
  s_cmp_gt_u32 s49, 200000
  s_cbranch_scc1 L_ok0
  s_waitcnt vmcnt(0)
  s_add_u32 s56, s62, 0
  buffer_load_dwordx4 v[64:67], v5, s[16:19], s56 offen offset:0 sc0 sc1
  buffer_load_dwordx4 v[68:71], v5, s[16:19], s56 offen offset:1024 sc0 sc1
  buffer_load_dwordx4 v[72:75], v5, s[16:19], s56 offen offset:2048 sc0 sc1
  buffer_load_dwordx4 v[76:79], v5, s[16:19], s56 offen offset:3072 sc0 sc1
  s_add_u32 s56, s62, 4096
  buffer_load_dwordx4 v[80:83], v5, s[16:19], s56 offen offset:0 sc0 sc1
  buffer_load_dwordx4 v[84:87], v5, s[16:19], s56 offen offset:1024 sc0 sc1
  buffer_load_dwordx4 v[88:91], v5, s[16:19], s56 offen offset:2048 sc0 sc1
  buffer_load_dwordx4 v[92:95], v5, s[16:19], s56 offen offset:3072 sc0 sc1
  s_add_u32 s56, s62, 8192
  buffer_load_dwordx4 v[96:99], v5, s[16:19], s56 offen offset:0 sc0 sc1
  buffer_load_dwordx4 v[100:103], v5, s[16:19], s56 offen offset:1024 sc0 sc1
  buffer_load_dwordx4 v[104:107], v5, s[16:19], s56 offen offset:2048 sc0 sc1
  buffer_load_dwordx4 v[108:111], v5, s[16:19], s56 offen offset:3072 sc0 sc1
  s_add_u32 s56, s62, 12288
  buffer_load_dwordx4 v[112:115], v5, s[16:19], s56 offen offset:0 sc0 sc1
  buffer_load_dwordx4 v[116:119], v5, s[16:19], s56 offen offset:1024 sc0 sc1
  buffer_load_dwordx4 v[120:123], v5, s[16:19], s56 offen offset:2048 sc0 sc1
  buffer_load_dwordx4 v[124:127], v5, s[16:19], s56 offen offset:3072 sc0 sc1
  s_waitcnt vmcnt(15)
  v_max3_u32 v3, v64, v65, v66
  v_max_u32 v3, v3, v67
  v_cmp_eq_u32 vcc, -1, v3
  s_nop 1
  s_cbranch_vccnz L_or0
  s_branch L_ok0
L_or1:
  s_add_u32 s49, s49, 1
  s_cmp_gt_u32 s49, 200000
  s_cbranch_scc1 L_ok1
  s_waitcnt vmcnt(0)
  s_add_u32 s56, s62, 0
  buffer_load_dwordx4 v[68:71], v5, s[16:19], s56 offen offset:1024 sc0 sc1
  buffer_load_dwordx4 v[72:75], v5, s[16:19], s56 offen offset:2048 sc0 sc1
  buffer_load_dwordx4 v[76:79], v5, s[16:19], s56 offen offset:3072 sc0 sc1
  s_add_u32 s56, s62, 4096
  buffer_load_dwordx4 v[80:83], v5, s[16:19], s56 offen offset:0 sc0 sc1
  buffer_load_dwordx4 v[84:87], v5, s[16:19], s56 offen offset:1024 sc0 sc1
  buffer_load_dwordx4 v[88:91], v5, s[16:19], s56 offen offset:2048 sc0 sc1
  buffer_load_dwordx4 v[92:95], v5, s[16:19], s56 offen offset:3072 sc0 sc1
  s_add_u32 s56, s62, 8192
  buffer_load_dwordx4 v[96:99], v5, s[16:19], s56 offen offset:0 sc0 sc1
  buffer_load_dwordx4 v[100:103], v5, s[16:19], s56 offen offset:1024 sc0 sc1
  buffer_load_dwordx4 v[104:107], v5, s[16:19], s56 offen offset:2048 sc0 sc1
  buffer_load_dwordx4 v[108:111], v5, s[16:19], s56 offen offset:3072 sc0 sc1
  s_add_u32 s56, s62, 12288
  buffer_load_dwordx4 v[112:115], v5, s[16:19], s56 offen offset:0 sc0 sc1
  buffer_load_dwordx4 v[116:119], v5, s[16:19], s56 offen offset:1024 sc0 sc1
  buffer_load_dwordx4 v[120:123], v5, s[16:19], s56 offen offset:2048 sc0 sc1
  buffer_load_dwordx4 v[124:127], v5, s[16:19], s56 offen offset:3072 sc0 sc1
  s_waitcnt vmcnt(14)
  v_max3_u32 v3, v68, v69, v70
  v_max_u32 v3, v3, v71
  v_cmp_eq_u32 vcc, -1, v3
  s_nop 1
  s_cbranch_vccnz L_or1
  s_branch L_ok1
L_or2:
  s_add_u32 s49, s49, 1
  s_cmp_gt_u32 s49, 200000
  s_cbranch_scc1 L_ok2
  s_waitcnt vmcnt(0)
  s_add_u32 s56, s62, 0
  buffer_load_dwordx4 v[72:75], v5, s[16:19], s56 offen offset:2048 sc0 sc1
  buffer_load_dwordx4 v[76:79], v5, s[16:19], s56 offen offset:3072 sc0 sc1
  s_add_u32 s56, s62, 4096
  buffer_load_dwordx4 v[80:83], v5, s[16:19], s56 offen offset:0 sc0 sc1
  buffer_load_dwordx4 v[84:87], v5, s[16:19], s56 offen offset:1024 sc0 sc1
  buffer_load_dwordx4 v[88:91], v5, s[16:19], s56 offen offset:2048 sc0 sc1
  buffer_load_dwordx4 v[92:95], v5, s[16:19], s56 offen offset:3072 sc0 sc1
  s_add_u32 s56, s62, 8192
  buffer_load_dwordx4 v[96:99], v5, s[16:19], s56 offen offset:0 sc0 sc1
  buffer_load_dwordx4 v[100:103], v5, s[16:19], s56 offen offset:1024 sc0 sc1
  buffer_load_dwordx4 v[104:107], v5, s[16:19], s56 offen offset:2048 sc0 sc1
  buffer_load_dwordx4 v[108:111], v5, s[16:19], s56 offen offset:3072 sc0 sc1
  s_add_u32 s56, s62, 12288
  buffer_load_dwordx4 v[112:115], v5, s[16:19], s56 offen offset:0 sc0 sc1
  buffer_load_dwordx4 v[116:119], v5, s[16:19], s56 offen offset:1024 sc0 sc1
  buffer_load_dwordx4 v[120:123], v5, s[16:19], s56 offen offset:2048 sc0 sc1
  buffer_load_dwordx4 v[124:127], v5, s[16:19], s56 offen offset:3072 sc0 sc1
  s_waitcnt vmcnt(13)
  v_max3_u32 v3, v72, v73, v74
  v_max_u32 v3, v3, v75
  v_cmp_eq_u32 vcc, -1, v3
  s_nop 1
  s_cbranch_vccnz L_or2
  s_branch L_ok2
L_or3:
  s_add_u32 s49, s49, 1
  s_cmp_gt_u32 s49, 200000
  s_cbranch_scc1 L_ok3
  s_waitcnt vmcnt(0)
  s_add_u32 s56, s62, 0
  buffer_load_dwordx4 v[76:79], v5, s[16:19], s56 offen offset:3072 sc0 sc1
  s_add_u32 s56, s62, 4096
  buffer_load_dwordx4 v[80:83], v5, s[16:19], s56 offen offset:0 sc0 sc1
  buffer_load_dwordx4 v[84:87], v5, s[16:19], s56 offen offset:1024 sc0 sc1
  buffer_load_dwordx4 v[88:91], v5, s[16:19], s56 offen offset:2048 sc0 sc1
  buffer_load_dwordx4 v[92:95], v5, s[16:19], s56 offen offset:3072 sc0 sc1
  s_add_u32 s56, s62, 8192
  buffer_load_dwordx4 v[96:99], v5, s[16:19], s56 offen offset:0 sc0 sc1
  buffer_load_dwordx4 v[100:103], v5, s[16:19], s56 offen offset:1024 sc0 sc1
  buffer_load_dwordx4 v[104:107], v5, s[16:19], s56 offen offset:2048 sc0 sc1
  buffer_load_dwordx4 v[108:111], v5, s[16:19], s56 offen offset:3072 sc0 sc1
  s_add_u32 s56, s62, 12288
  buffer_load_dwordx4 v[112:115], v5, s[16:19], s56 offen offset:0 sc0 sc1
  buffer_load_dwordx4 v[116:119], v5, s[16:19], s56 offen offset:1024 sc0 sc1
  buffer_load_dwordx4 v[120:123], v5, s[16:19], s56 offen offset:2048 sc0 sc1
  buffer_load_dwordx4 v[124:127], v5, s[16:19], s56 offen offset:3072 sc0 sc1
  s_waitcnt vmcnt(12)
  v_max3_u32 v3, v76, v77, v78
  v_max_u32 v3, v3, v79
  v_cmp_eq_u32 vcc, -1, v3
  s_nop 1
  s_cbranch_vccnz L_or3
  s_branch L_ok3
L_or4:
  s_add_u32 s49, s49, 1
  s_cmp_gt_u32 s49, 200000
  s_cbranch_scc1 L_ok4
  s_waitcnt vmcnt(0)
  s_add_u32 s56, s62, 4096
  buffer_load_dwordx4 v[80:83], v5, s[16:19], s56 offen offset:0 sc0 sc1
  buffer_load_dwordx4 v[84:87], v5, s[16:19], s56 offen offset:1024 sc0 sc1
  buffer_load_dwordx4 v[88:91], v5, s[16:19], s56 offen offset:2048 sc0 sc1
  buffer_load_dwordx4 v[92:95], v5, s[16:19], s56 offen offset:3072 sc0 sc1
  s_add_u32 s56, s62, 8192
  buffer_load_dwordx4 v[96:99], v5, s[16:19], s56 offen offset:0 sc0 sc1
  buffer_load_dwordx4 v[100:103], v5, s[16:19], s56 offen offset:1024 sc0 sc1
  buffer_load_dwordx4 v[104:107], v5, s[16:19], s56 offen offset:2048 sc0 sc1
  buffer_load_dwordx4 v[108:111], v5, s[16:19], s56 offen offset:3072 sc0 sc1
  s_add_u32 s56, s62, 12288
  buffer_load_dwordx4 v[112:115], v5, s[16:19], s56 offen offset:0 sc0 sc1
  buffer_load_dwordx4 v[116:119], v5, s[16:19], s56 offen offset:1024 sc0 sc1
  buffer_load_dwordx4 v[120:123], v5, s[16:19], s56 offen offset:2048 sc0 sc1
  buffer_load_dwordx4 v[124:127], v5, s[16:19], s56 offen offset:3072 sc0 sc1
  s_waitcnt vmcnt(11)
  v_max3_u32 v3, v80, v81, v82
  v_max_u32 v3, v3, v83
  v_cmp_eq_u32 vcc, -1, v3
  s_nop 1
  s_cbranch_vccnz L_or4
  s_branch L_ok4
L_or5:
  s_add_u32 s49, s49, 1
  s_cmp_gt_u32 s49, 200000
  s_cbranch_scc1 L_ok5
  s_waitcnt vmcnt(0)
  s_add_u32 s56, s62, 4096
  buffer_load_dwordx4 v[84:87], v5, s[16:19], s56 offen offset:1024 sc0 sc1
  buffer_load_dwordx4 v[88:91], v5, s[16:19], s56 offen offset:2048 sc0 sc1
  buffer_load_dwordx4 v[92:95], v5, s[16:19], s56 offen offset:3072 sc0 sc1
  s_add_u32 s56, s62, 8192
  buffer_load_dwordx4 v[96:99], v5, s[16:19], s56 offen offset:0 sc0 sc1
  buffer_load_dwordx4 v[100:103], v5, s[16:19], s56 offen offset:1024 sc0 sc1
  buffer_load_dwordx4 v[104:107], v5, s[16:19], s56 offen offset:2048 sc0 sc1
  buffer_load_dwordx4 v[108:111], v5, s[16:19], s56 offen offset:3072 sc0 sc1
  s_add_u32 s56, s62, 12288
  buffer_load_dwordx4 v[112:115], v5, s[16:19], s56 offen offset:0 sc0 sc1
  buffer_load_dwordx4 v[116:119], v5, s[16:19], s56 offen offset:1024 sc0 sc1
  buffer_load_dwordx4 v[120:123], v5, s[16:19], s56 offen offset:2048 sc0 sc1
  buffer_load_dwordx4 v[124:127], v5, s[16:19], s56 offen offset:3072 sc0 sc1
  s_waitcnt vmcnt(10)
  v_max3_u32 v3, v84, v85, v86
  v_max_u32 v3, v3, v87
  v_cmp_eq_u32 vcc, -1, v3
  s_nop 1
  s_cbranch_vccnz L_or5
  s_branch L_ok5
L_or6:
  s_add_u32 s49, s49, 1
  s_cmp_gt_u32 s49, 200000
  s_cbranch_scc1 L_ok6
  s_waitcnt vmcnt(0)
  s_add_u32 s56, s62, 4096
  buffer_load_dwordx4 v[88:91], v5, s[16:19], s56 offen offset:2048 sc0 sc1
  buffer_load_dwordx4 v[92:95], v5, s[16:19], s56 offen offset:3072 sc0 sc1
  s_add_u32 s56, s62, 8192
  buffer_load_dwordx4 v[96:99], v5, s[16:19], s56 offen offset:0 sc0 sc1
  buffer_load_dwordx4 v[100:103], v5, s[16:19], s56 offen offset:1024 sc0 sc1
  buffer_load_dwordx4 v[104:107], v5, s[16:19], s56 offen offset:2048 sc0 sc1
  buffer_load_dwordx4 v[108:111], v5, s[16:19], s56 offen offset:3072 sc0 sc1
  s_add_u32 s56, s62, 12288
  buffer_load_dwordx4 v[112:115], v5, s[16:19], s56 offen offset:0 sc0 sc1
  buffer_load_dwordx4 v[116:119], v5, s[16:19], s56 offen offset:1024 sc0 sc1
  buffer_load_dwordx4 v[120:123], v5, s[16:19], s56 offen offset:2048 sc0 sc1
  buffer_load_dwordx4 v[124:127], v5, s[16:19], s56 offen offset:3072 sc0 sc1
  s_waitcnt vmcnt(9)
  v_max3_u32 v3, v88, v89, v90
  v_max_u32 v3, v3, v91
  v_cmp_eq_u32 vcc, -1, v3
  s_nop 1
  s_cbranch_vccnz L_or6
  s_branch L_ok6
L_or7:
  s_add_u32 s49, s49, 1
  s_cmp_gt_u32 s49, 200000
  s_cbranch_scc1 L_ok7
  s_waitcnt vmcnt(0)
  s_add_u32 s56, s62, 4096
  buffer_load_dwordx4 v[92:95], v5, s[16:19], s56 offen offset:3072 sc0 sc1
  s_add_u32 s56, s62, 8192
  buffer_load_dwordx4 v[96:99], v5, s[16:19], s56 offen offset:0 sc0 sc1
  buffer_load_dwordx4 v[100:103], v5, s[16:19], s56 offen offset:1024 sc0 sc1
  buffer_load_dwordx4 v[104:107], v5, s[16:19], s56 offen offset:2048 sc0 sc1
  buffer_load_dwordx4 v[108:111], v5, s[16:19], s56 offen offset:3072 sc0 sc1
  s_add_u32 s56, s62, 12288
  buffer_load_dwordx4 v[112:115], v5, s[16:19], s56 offen offset:0 sc0 sc1
  buffer_load_dwordx4 v[116:119], v5, s[16:19], s56 offen offset:1024 sc0 sc1
  buffer_load_dwordx4 v[120:123], v5, s[16:19], s56 offen offset:2048 sc0 sc1
  buffer_load_dwordx4 v[124:127], v5, s[16:19], s56 offen offset:3072 sc0 sc1
  s_waitcnt vmcnt(8)
  v_max3_u32 v3, v92, v93, v94
  v_max_u32 v3, v3, v95
  v_cmp_eq_u32 vcc, -1, v3
  s_nop 1
  s_cbranch_vccnz L_or7
  s_branch L_ok7
L_or8:
  s_add_u32 s49, s49, 1
  s_cmp_gt_u32 s49, 200000
  s_cbranch_scc1 L_ok8
  s_waitcnt vmcnt(0)
  s_add_u32 s56, s62, 8192
  buffer_load_dwordx4 v[96:99], v5, s[16:19], s56 offen offset:0 sc0 sc1
  buffer_load_dwordx4 v[100:103], v5, s[16:19], s56 offen offset:1024 sc0 sc1
  buffer_load_dwordx4 v[104:107], v5, s[16:19], s56 offen offset:2048 sc0 sc1
  buffer_load_dwordx4 v[108:111], v5, s[16:19], s56 offen offset:3072 sc0 sc1
  s_add_u32 s56, s62, 12288
  buffer_load_dwordx4 v[112:115], v5, s[16:19], s56 offen offset:0 sc0 sc1
  buffer_load_dwordx4 v[116:119], v5, s[16:19], s56 offen offset:1024 sc0 sc1
  buffer_load_dwordx4 v[120:123], v5, s[16:19], s56 offen offset:2048 sc0 sc1
  buffer_load_dwordx4 v[124:127], v5, s[16:19], s56 offen offset:3072 sc0 sc1
  s_waitcnt vmcnt(7)
  v_max3_u32 v3, v96, v97, v98
  v_max_u32 v3, v3, v99
  v_cmp_eq_u32 vcc, -1, v3
  s_nop 1
  s_cbranch_vccnz L_or8
  s_branch L_ok8
L_or9:
  s_add_u32 s49, s49, 1
  s_cmp_gt_u32 s49, 200000
  s_cbranch_scc1 L_ok9
  s_waitcnt vmcnt(0)
  s_add_u32 s56, s62, 8192
  buffer_load_dwordx4 v[100:103], v5, s[16:19], s56 offen offset:1024 sc0 sc1
  buffer_load_dwordx4 v[104:107], v5, s[16:19], s56 offen offset:2048 sc0 sc1
  buffer_load_dwordx4 v[108:111], v5, s[16:19], s56 offen offset:3072 sc0 sc1
  s_add_u32 s56, s62, 12288
  buffer_load_dwordx4 v[112:115], v5, s[16:19], s56 offen offset:0 sc0 sc1
  buffer_load_dwordx4 v[116:119], v5, s[16:19], s56 offen offset:1024 sc0 sc1
  buffer_load_dwordx4 v[120:123], v5, s[16:19], s56 offen offset:2048 sc0 sc1
  buffer_load_dwordx4 v[124:127], v5, s[16:19], s56 offen offset:3072 sc0 sc1
  s_waitcnt vmcnt(6)
  v_max3_u32 v3, v100, v101, v102
  v_max_u32 v3, v3, v103
  v_cmp_eq_u32 vcc, -1, v3
  s_nop 1
  s_cbranch_vccnz L_or9
  s_branch L_ok9
L_or10:
  s_add_u32 s49, s49, 1
  s_cmp_gt_u32 s49, 200000
  s_cbranch_scc1 L_ok10
  s_waitcnt vmcnt(0)
  s_add_u32 s56, s62, 8192
  buffer_load_dwordx4 v[104:107], v5, s[16:19], s56 offen offset:2048 sc0 sc1
  buffer_load_dwordx4 v[108:111], v5, s[16:19], s56 offen offset:3072 sc0 sc1
  s_add_u32 s56, s62, 12288
  buffer_load_dwordx4 v[112:115], v5, s[16:19], s56 offen offset:0 sc0 sc1
  buffer_load_dwordx4 v[116:119], v5, s[16:19], s56 offen offset:1024 sc0 sc1
  buffer_load_dwordx4 v[120:123], v5, s[16:19], s56 offen offset:2048 sc0 sc1
  buffer_load_dwordx4 v[124:127], v5, s[16:19], s56 offen offset:3072 sc0 sc1
  s_waitcnt vmcnt(5)
  v_max3_u32 v3, v104, v105, v106
  v_max_u32 v3, v3, v107
  v_cmp_eq_u32 vcc, -1, v3
  s_nop 1
  s_cbranch_vccnz L_or10
  s_branch L_ok10
L_or11:
  s_add_u32 s49, s49, 1
  s_cmp_gt_u32 s49, 200000
  s_cbranch_scc1 L_ok11
  s_waitcnt vmcnt(0)
  s_add_u32 s56, s62, 8192
  buffer_load_dwordx4 v[108:111], v5, s[16:19], s56 offen offset:3072 sc0 sc1
  s_add_u32 s56, s62, 12288
  buffer_load_dwordx4 v[112:115], v5, s[16:19], s56 offen offset:0 sc0 sc1
  buffer_load_dwordx4 v[116:119], v5, s[16:19], s56 offen offset:1024 sc0 sc1
  buffer_load_dwordx4 v[120:123], v5, s[16:19], s56 offen offset:2048 sc0 sc1
  buffer_load_dwordx4 v[124:127], v5, s[16:19], s56 offen offset:3072 sc0 sc1
  s_waitcnt vmcnt(4)
  v_max3_u32 v3, v108, v109, v110
  v_max_u32 v3, v3, v111
  v_cmp_eq_u32 vcc, -1, v3
  s_nop 1
  s_cbranch_vccnz L_or11
  s_branch L_ok11
L_or12:
  s_add_u32 s49, s49, 1
  s_cmp_gt_u32 s49, 200000
  s_cbranch_scc1 L_ok12
  s_waitcnt vmcnt(0)
  s_add_u32 s56, s62, 12288
  buffer_load_dwordx4 v[112:115], v5, s[16:19], s56 offen offset:0 sc0 sc1
  buffer_load_dwordx4 v[116:119], v5, s[16:19], s56 offen offset:1024 sc0 sc1
  buffer_load_dwordx4 v[120:123], v5, s[16:19], s56 offen offset:2048 sc0 sc1
  buffer_load_dwordx4 v[124:127], v5, s[16:19], s56 offen offset:3072 sc0 sc1
  s_waitcnt vmcnt(3)
  v_max3_u32 v3, v112, v113, v114
  v_max_u32 v3, v3, v115
  v_cmp_eq_u32 vcc, -1, v3
  s_nop 1
  s_cbranch_vccnz L_or12
  s_branch L_ok12
L_or13:
  s_add_u32 s49, s49, 1
  s_cmp_gt_u32 s49, 200000
  s_cbranch_scc1 L_ok13
  s_waitcnt vmcnt(0)
  s_add_u32 s56, s62, 12288
  buffer_load_dwordx4 v[116:119], v5, s[16:19], s56 offen offset:1024 sc0 sc1
  buffer_load_dwordx4 v[120:123], v5, s[16:19], s56 offen offset:2048 sc0 sc1
  buffer_load_dwordx4 v[124:127], v5, s[16:19], s56 offen offset:3072 sc0 sc1
  s_waitcnt vmcnt(2)
  v_max3_u32 v3, v116, v117, v118
  v_max_u32 v3, v3, v119
  v_cmp_eq_u32 vcc, -1, v3
  s_nop 1
  s_cbranch_vccnz L_or13
  s_branch L_ok13
L_or14:
  s_add_u32 s49, s49, 1
  s_cmp_gt_u32 s49, 200000
  s_cbranch_scc1 L_ok14
  s_waitcnt vmcnt(0)
  s_add_u32 s56, s62, 12288
  buffer_load_dwordx4 v[120:123], v5, s[16:19], s56 offen offset:2048 sc0 sc1
  buffer_load_dwordx4 v[124:127], v5, s[16:19], s56 offen offset:3072 sc0 sc1
  s_waitcnt vmcnt(1)
  v_max3_u32 v3, v120, v121, v122
  v_max_u32 v3, v3, v123
  v_cmp_eq_u32 vcc, -1, v3
  s_nop 1
  s_cbranch_vccnz L_or14
  s_branch L_ok14
L_or15:
  s_add_u32 s49, s49, 1
  s_cmp_gt_u32 s49, 200000
  s_cbranch_scc1 L_ok15
  s_waitcnt vmcnt(0)
  s_add_u32 s56, s62, 12288
  buffer_load_dwordx4 v[124:127], v5, s[16:19], s56 offen offset:3072 sc0 sc1
  s_waitcnt vmcnt(0)
  v_max3_u32 v3, v124, v125, v126
  v_max_u32 v3, v3, v127
  v_cmp_eq_u32 vcc, -1, v3
  s_nop 1
  s_cbranch_vccnz L_or15
  s_branch L_ok15
L_exit:
  s_endpgm
.section .rodata,"a"
.p2align 6
.amdhsa_kernel gated_mix__ssm_conv_s5__softmax_full_mha__prompt_kernel
  .amdhsa_next_free_vgpr 168
  .amdhsa_next_free_sgpr 100
  .amdhsa_accum_offset 168
  .amdhsa_group_segment_fixed_size 0
  .amdhsa_kernarg_size 128
  .amdhsa_user_sgpr_count 2
  .amdhsa_user_sgpr_kernarg_segment_ptr 1
  .amdhsa_system_sgpr_workgroup_id_x 1
.end_amdhsa_kernel
```
